```python
import torch

def _softmax(x, axis=-1):
    return torch.softmax(x, dim=axis)
def _gelu(x):
    return torch.nn.functional.gelu(x, approximate="tanh")
def _silu(x):
    return torch.nn.functional.silu(x)
def _sigmoid(x):
    return torch.sigmoid(x)
def _layernorm(x, axis=-1, eps=1e-5):
    m = x.mean(dim=axis, keepdim=True)
    v = x.var(dim=axis, keepdim=True, unbiased=False)
    return (x - m) / torch.sqrt(v + eps)
def _scatter_add(tgt, idx, src, axis=0):
    return tgt.clone().index_add_(axis, idx, src)
def _segment_sum(src, seg, n):
    out = torch.zeros((n,) + src.shape[1:], dtype=src.dtype)
    return out.index_add_(0, seg, src)
def _pad(x, pw):
    flat = tuple(v for pair in reversed(pw) for v in pair)
    return torch.nn.functional.pad(x, flat)

kernel_name = 'standalone__dense_activation_squared_relu__prompt'

def setup_inputs():

    _w = (lambda a: (lambda t: t.to(torch.bfloat16) if t.is_floating_point() else t)(torch.as_tensor(a)))
    B, S, D, F = 1, 2048, 576, 4608
    return {
        "x": _w((lambda *s: torch.randn(*s, dtype=torch.bfloat16) * 0.05)(B, S, D)),
        "w1": _w((lambda *s: torch.randn(*s, dtype=torch.bfloat16) * 0.05)(D, F)),
        "b1": _w((lambda *s: torch.randn(*s, dtype=torch.bfloat16) * 0.05)(F)),
        "w2": _w((lambda *s: torch.randn(*s, dtype=torch.bfloat16) * 0.05)(F, D)),
        "b2": _w((lambda *s: torch.randn(*s, dtype=torch.bfloat16) * 0.05)(D)),
    }

def reference(x, w1, b1, w2, b2):
    h = torch.einsum("bsd,df->bsf", x, w1) + b1
    zero = torch.zeros_like(h)
    r = torch.where(h > zero, h, zero)
    h = r * r
    out = torch.einsum("bsf,fd->bsd", h, w2) + b2
    return out
```

```asm
; @launch grid=(256,1,1) block=(256,1,1) lds=163840
.amdgcn_target "amdgcn-amd-amdhsa--gfx950"
.text
.globl standalone__dense_activation_squared_relu__prompt_kernel
.p2align 8
.type standalone__dense_activation_squared_relu__prompt_kernel,@function
standalone__dense_activation_squared_relu__prompt_kernel:
    s_cmp_ge_u32 s2, 256
    s_cbranch_scc1 L_main_end
    s_load_dwordx4 s[4:7], s[0:1], 0
    s_load_dwordx4 s[96:99], s[0:1], 16
    s_load_dwordx8 s[84:91], s[0:1], 32
    s_memrealtime s[100:101]
    s_getpc_b64 s[38:39]
L_pc_ref:
    v_lshrrev_b32 v1, 6, v0
    v_and_b32 v2, 63, v0
    v_readfirstlane_b32 s30, v1
    s_and_b32 s3, s2, 7
    s_lshr_b32 s93, s2, 3
    s_and_b32 s94, s3, 1
    s_lshr_b32 s3, s3, 1
    s_lshl_b32 s94, s94, 4
    s_lshr_b32 s36, s93, 1
    s_add_u32 s28, s94, s36
    s_lshl_b32 s3, s3, 1
    s_and_b32 s94, s93, 1
    s_add_u32 s29, s3, s94
    s_lshl_b32 s31, s30, 11
    s_add_u32 s3, s29, s28
    s_and_b32 s3, s3, 7
    s_mul_i32 s94, s93, 1536
    v_lshlrev_b32 v8, 7, v0
    v_add_u32 v8, s94, v8
    s_mov_b32 s94, L_main_end-L_pc_ref-4
    v_min_u32 v8, s94, v8
    v_cmp_gt_u32 vcc, 12, v0
    s_and_saveexec_b64 s[80:81], vcc
    s_cbranch_execz L_nocodepf
    global_load_dword v222, v8, s[38:39]
L_nocodepf:
    s_mov_b64 exec, s[80:81]
    s_cmp_ge_u32 s36, 9
    s_cselect_b32 s94, 9, 0
    s_sub_u32 s36, s36, s94
    s_lshl_b32 s58, s36, 7
    s_mov_b32 s40, 0
    s_mov_b32 s41, 589824
    s_mov_b32 s42, 1179648
    s_mov_b32 s43, 1769472
    s_mov_b32 s44, 2359296
    s_mov_b32 s45, 2949120
    s_mov_b32 s46, 3538944
    s_mov_b32 s47, 4128768
    s_mov_b32 s48, 4718592
    v_lshrrev_b32 v3, 3, v2
    v_and_b32 v4, 7, v2
    v_lshrrev_b32 v5, 4, v2
    v_and_b32 v6, 15, v2
    s_and_b32 s93, s30, 1
    s_lshl_b32 s93, s93, 2
    v_add_u32 v8, s93, v5
    v_xor_b32 v8, v8, v4
    v_lshlrev_b32 v8, 4, v8
    s_lshl_b32 s93, s30, 3
    v_add_u32 v7, s93, v3
    v_mul_u32_u24 v7, 1152, v7
    v_add_u32 v226, v7, v8
    v_lshlrev_b32 v224, 3, v0
    v_and_b32 v9, 1, v5
    v_lshrrev_b32 v10, 5, v2
    v_lshrrev_b32 v11, 1, v4
    v_and_b32 v12, 1, v4
    s_lshl_b32 s93, s30, 4
    s_add_u32 s93, s93, 0
    v_add_u32 v14, s93, v3
    v_xor_b32 v13, 0, v10
    v_lshl_or_b32 v13, v13, 1, v9
    v_xor_b32 v13, v13, v11
    v_lshl_or_b32 v13, v13, 1, v12
    v_lshlrev_b32 v13, 4, v13
    v_mul_u32_u24 v7, 9216, v14
    v_add_u32 v7, v7, v13
    v_mul_u32_u24 v8, 1152, v14
    v_add_u32 v8, v8, v13
    v_mov_b32 v208, v7
    v_mov_b32 v212, v8
    v_add_u32 v206, s58, v7
    v_mov_b32 v210, v8
    s_lshl_b32 s93, s30, 4
    s_add_u32 s93, s93, 8
    v_add_u32 v14, s93, v3
    v_xor_b32 v13, 1, v10
    v_lshl_or_b32 v13, v13, 1, v9
    v_xor_b32 v13, v13, v11
    v_lshl_or_b32 v13, v13, 1, v12
    v_lshlrev_b32 v13, 4, v13
    v_mul_u32_u24 v7, 9216, v14
    v_add_u32 v7, v7, v13
    v_mul_u32_u24 v8, 1152, v14
    v_add_u32 v8, v8, v13
    v_subrev_u32 v7, 1024, v7
    v_subrev_u32 v8, 1024, v8
    v_mov_b32 v209, v7
    v_mov_b32 v213, v8
    v_add_u32 v207, s58, v7
    v_mov_b32 v211, v8
    s_lshl_b32 s92, s30, 10
    s_waitcnt lgkmcnt(0)
    s_mul_i32 s95, s28, 73728
    s_add_u32 s8, s4, s95
    s_addc_u32 s9, s5, 0
    s_mov_b32 s10, 73728
    s_mov_b32 s11, 0x20000
    s_mul_i32 s95, s29, 1152
    s_add_u32 s24, s96, s95
    s_addc_u32 s25, s97, 0
    s_mov_b32 s26, 1152
    s_mov_b32 s27, 0x20000
    buffer_load_dwordx2 v[224:225], v224, s[24:27], 0 offen
    s_add_u32 m0, s92, 0
    s_mov_b32 s34, 0
    buffer_load_dwordx4 v226, s[8:11], s34 offen lds
    s_add_u32 m0, s92, 4096
    s_mov_b32 s35, 36864
    buffer_load_dwordx4 v226, s[8:11], s35 offen lds
    s_add_u32 s12, s6, s95
    s_addc_u32 s13, s7, 0
    s_sub_u32 s14, 5308416, s95
    s_mov_b32 s15, 0x20000
    s_add_u32 m0, s92, 8192
    s_mov_b32 s34, 128
    buffer_load_dwordx4 v226, s[8:11], s34 offen lds
    s_add_u32 m0, s92, 12288
    s_mov_b32 s35, 36992
    buffer_load_dwordx4 v226, s[8:11], s35 offen lds
    s_add_u32 s94, s36, 0
    s_cmp_ge_u32 s94, 9
    s_cselect_b32 s95, 9, 0
    s_sub_u32 s94, s94, s95
    s_lshl_b32 s58, s94, 7
    s_mul_i32 s49, s94, 73728
    s_mov_b32 s67, 1024
    s_add_u32 s94, s36, 1
    s_cmp_ge_u32 s94, 9
    s_cselect_b32 s95, 9, 0
    s_sub_u32 s94, s94, s95
    s_lshl_b32 s59, s94, 7
    s_mul_i32 s50, s94, 73728
    s_add_u32 s94, s3, 1
    s_and_b32 s94, s94, 7
    s_lshl_b32 s68, s94, 7
    s_add_u32 s94, s36, 2
    s_cmp_ge_u32 s94, 9
    s_cselect_b32 s95, 9, 0
    s_sub_u32 s94, s94, s95
    s_lshl_b32 s60, s94, 7
    s_mul_i32 s51, s94, 73728
    s_add_u32 s94, s3, 2
    s_and_b32 s94, s94, 7
    s_lshl_b32 s69, s94, 7
    s_add_u32 s94, s36, 3
    s_cmp_ge_u32 s94, 9
    s_cselect_b32 s95, 9, 0
    s_sub_u32 s94, s94, s95
    s_lshl_b32 s61, s94, 7
    s_mul_i32 s52, s94, 73728
    s_add_u32 s94, s3, 3
    s_and_b32 s94, s94, 7
    s_lshl_b32 s70, s94, 7
    s_add_u32 s94, s36, 4
    s_cmp_ge_u32 s94, 9
    s_cselect_b32 s95, 9, 0
    s_sub_u32 s94, s94, s95
    s_lshl_b32 s62, s94, 7
    s_mul_i32 s53, s94, 73728
    s_add_u32 s94, s3, 4
    s_and_b32 s94, s94, 7
    s_lshl_b32 s71, s94, 7
    s_add_u32 s94, s36, 5
    s_cmp_ge_u32 s94, 9
    s_cselect_b32 s95, 9, 0
    s_sub_u32 s94, s94, s95
    s_lshl_b32 s63, s94, 7
    s_mul_i32 s54, s94, 73728
    s_add_u32 s94, s3, 5
    s_and_b32 s94, s94, 7
    s_lshl_b32 s72, s94, 7
    s_add_u32 s94, s36, 6
    s_cmp_ge_u32 s94, 9
    s_cselect_b32 s95, 9, 0
    s_sub_u32 s94, s94, s95
    s_lshl_b32 s64, s94, 7
    s_mul_i32 s55, s94, 73728
    s_add_u32 s94, s3, 6
    s_and_b32 s94, s94, 7
    s_lshl_b32 s73, s94, 7
    s_add_u32 s94, s36, 7
    s_cmp_ge_u32 s94, 9
    s_cselect_b32 s95, 9, 0
    s_sub_u32 s94, s94, s95
    s_lshl_b32 s65, s94, 7
    s_mul_i32 s56, s94, 73728
    s_add_u32 s94, s3, 7
    s_and_b32 s94, s94, 7
    s_lshl_b32 s74, s94, 7
    s_add_u32 s94, s36, 8
    s_cmp_ge_u32 s94, 9
    s_cselect_b32 s95, 9, 0
    s_sub_u32 s94, s94, s95
    s_lshl_b32 s66, s94, 7
    s_mul_i32 s57, s94, 73728
    s_add_u32 s94, s3, 8
    s_and_b32 s94, s94, 7
    s_lshl_b32 s75, s94, 7
    v_lshrrev_b32 v8, 2, v6
    v_lshrrev_b32 v9, 3, v6
    v_and_b32 v10, 1, v5
    v_and_b32 v11, 3, v6
    v_lshlrev_b32 v11, 3, v11
    v_lshl_add_u32 v12, v5, 3, v8
    v_lshlrev_b32 v12, 7, v12
    v_add_u32 v12, v12, v11
    v_xor_b32 v13, 0, v10
    v_lshl_or_b32 v13, v13, 1, v9
    v_xor_b32 v13, s30, v13
    v_lshl_add_u32 v196, v13, 5, v12
    v_lshl_add_u32 v12, v5, 3, v8
    v_add_u32 v12, 4, v12
    v_lshlrev_b32 v12, 7, v12
    v_add_u32 v12, v12, v11
    v_xor_b32 v13, 1, v10
    v_lshl_or_b32 v13, v13, 1, v9
    v_xor_b32 v13, s30, v13
    v_lshl_add_u32 v197, v13, 5, v12
    v_add_u32 v198, 65536, v196
    v_add_u32 v199, 65536, v197
    v_add_u32 v200, 131072, v196
    v_add_u32 v201, 131072, v197
    v_lshl_add_u32 v12, v5, 2, v8
    v_lshlrev_b32 v12, 7, v12
    v_add_u32 v12, v12, v11
    v_lshrrev_b32 v13, 1, v5
    v_xor_b32 v13, v13, v10
    v_lshl_or_b32 v13, v13, 1, v9
    v_xor_b32 v13, s30, v13
    v_lshl_add_u32 v202, v13, 5, v12
    v_add_u32 v203, 65536, v202
    v_add_u32 v204, 131072, v202
    v_lshrrev_b32 v12, 1, v6
    v_lshlrev_b32 v13, 7, v6
    v_add_u32 v15, 0, v5
    v_xor_b32 v15, v15, v12
    v_lshl_add_u32 v214, v15, 4, v13
    v_add_u32 v216, 32768, v214
    v_add_u32 v15, 4, v5
    v_xor_b32 v15, v15, v12
    v_lshl_add_u32 v215, v15, 4, v13
    v_add_u32 v217, 32768, v215
    v_lshlrev_b32 v13, 4, v2
    v_add_u32 v219, 122880, v13
    s_lshr_b32 s93, s30, 1
    s_lshl_b32 s93, s93, 12
    s_and_b32 s94, s30, 1
    s_lshl_b32 s94, s94, 3
    s_add_u32 s93, s93, s94
    v_add_u32 v218, s93, v219
    s_lshl_b32 s93, s30, 12
    v_add_u32 v248, s93, v219
    s_add_u32 s93, s30, 1
    s_and_b32 s93, s93, 3
    s_lshl_b32 s93, s93, 12
    v_add_u32 v249, s93, v219
    s_add_u32 s93, s30, 2
    s_and_b32 s93, s93, 3
    s_lshl_b32 s93, s93, 12
    v_add_u32 v250, s93, v219
    s_add_u32 s93, s30, 3
    s_and_b32 s93, s93, 3
    s_lshl_b32 s93, s93, 12
    v_add_u32 v251, s93, v219
    v_add_u32 v240, s31, v13
    s_lshl_b32 s93, s29, 13
    v_add_u32 v221, s93, v240
    s_lshl_b32 s93, s30, 6
    s_add_u32 s93, s93, 155648
    v_lshlrev_b32 v13, 4, v5
    v_add_u32 v220, s93, v13
    s_lshl_b32 s93, s36, 8
    v_lshlrev_b32 v7, 4, v0
    v_subrev_u32 v13, s93, v7
    v_add_u32 v14, 2304, v13
    v_cmp_gt_u32 vcc, s93, v7
    s_nop 1
    v_cndmask_b32 v13, v13, v14, vcc
    v_cmp_lt_u32 vcc, 143, v0
    s_nop 1
    v_cndmask_b32 v13, v13, v7, vcc
    v_add_u32 v227, 155648, v13
    v_lshrrev_b32 v13, 2, v6
    v_cmp_eq_u32 vcc, v13, v5
    v_and_b32 v14, 1, v6
    v_lshlrev_b32 v14, 4, v14
    v_mov_b32 v15, 0x3f80
    v_lshlrev_b32 v14, v14, v15
    v_cndmask_b32 v14, 0, v14, vcc
    v_bfe_u32 v13, v6, 1, 1
    v_cmp_eq_u32 vcc, 0, v13
    s_nop 1
    v_cndmask_b32 v228, 0, v14, vcc
    v_mov_b32 v234, v228
    v_cmp_eq_u32 vcc, 1, v13
    s_nop 1
    v_cndmask_b32 v229, 0, v14, vcc
    v_mov_b32 v235, v229
    v_mov_b32 v230, 0
    v_mov_b32 v231, 0
    v_mov_b32 v232, 0
    v_mov_b32 v233, 0
    v_mov_b32 v7, 1073741824
    s_lshl_b32 s93, s29, 7
    s_add_u32 s93, s93, 589824
    v_mov_b32 v8, s93
    v_cmp_eq_u32 vcc, 0, v0
    s_nop 1
    v_cndmask_b32 v236, v7, v8, vcc
    s_lshl_b32 s93, s28, 2
    v_mov_b32 v8, s93
    v_cndmask_b32 v245, v7, v8, vcc
    s_cmp_eq_u32 s29, 0
    s_cbranch_scc1 L_lead
    v_mov_b32 v245, v7
L_lead:
    v_cmp_eq_u32 vcc, 0, v2
    s_nop 1
    v_cndmask_b32 v243, v7, v8, vcc
    v_lshlrev_b32 v8, 7, v2
    v_add_u32 v8, 589824, v8
    v_cmp_gt_u32 vcc, 8, v2
    s_nop 1
    v_cndmask_b32 v238, v7, v8, vcc
    v_and_b32 v14, 1, v5
    v_lshl_add_u32 v13, v14, 4, v6
    v_mul_u32_u24 v13, 1152, v13
    v_lshrrev_b32 v15, 1, v5
    v_lshl_add_u32 v13, v15, 4, v13
    s_lshl_b32 s93, s30, 5
    v_add_u32 v241, s93, v13
    v_lshlrev_b32 v13, 3, v5
    v_add_u32 v242, s93, v13
    s_add_u32 m0, s92, 16384
    s_mov_b32 s34, 256
    buffer_load_dwordx4 v226, s[8:11], s34 offen lds
    s_add_u32 m0, s92, 20480
    s_mov_b32 s35, 37120
    buffer_load_dwordx4 v226, s[8:11], s35 offen lds
    s_add_u32 m0, s92, 24576
    s_mov_b32 s34, 384
    buffer_load_dwordx4 v226, s[8:11], s34 offen lds
    s_add_u32 m0, s92, 28672
    s_mov_b32 s35, 37248
    buffer_load_dwordx4 v226, s[8:11], s35 offen lds
    s_add_u32 m0, s92, 32768
    s_mov_b32 s34, 512
    buffer_load_dwordx4 v226, s[8:11], s34 offen lds
    s_add_u32 m0, s92, 36864
    s_mov_b32 s35, 37376
    buffer_load_dwordx4 v226, s[8:11], s35 offen lds
    s_add_u32 m0, s92, 40960
    s_mov_b32 s34, 640
    buffer_load_dwordx4 v226, s[8:11], s34 offen lds
    s_add_u32 m0, s92, 45056
    s_mov_b32 s35, 37504
    buffer_load_dwordx4 v226, s[8:11], s35 offen lds
    s_add_u32 m0, s92, 49152
    s_mov_b32 s34, 768
    buffer_load_dwordx4 v226, s[8:11], s34 offen lds
    s_add_u32 m0, s92, 53248
    s_mov_b32 s35, 37632
    buffer_load_dwordx4 v226, s[8:11], s35 offen lds
    s_add_u32 m0, s92, 57344
    s_mov_b32 s34, 896
    buffer_load_dwordx4 v226, s[8:11], s34 offen lds
    s_add_u32 m0, s92, 61440
    s_mov_b32 s35, 37760
    buffer_load_dwordx4 v226, s[8:11], s35 offen lds
    s_add_u32 m0, s92, 65536
    s_mov_b32 s34, 1024
    buffer_load_dwordx4 v226, s[8:11], s34 offen lds
    s_add_u32 m0, s92, 69632
    s_mov_b32 s35, 37888
    buffer_load_dwordx4 v226, s[8:11], s35 offen lds
    s_add_u32 m0, s31, 73728
    s_nop 0
    buffer_load_dwordx4 v206, s[12:15], s40 offen offset:0 lds
    buffer_load_dwordx4 v207, s[12:15], s40 offen offset:1024 lds
    s_add_u32 m0, s31, 81920
    s_nop 0
    buffer_load_dwordx4 v206, s[12:15], s41 offen offset:0 lds
    buffer_load_dwordx4 v207, s[12:15], s41 offen offset:1024 lds
    s_add_u32 m0, s31, 90112
    s_nop 0
    buffer_load_dwordx4 v206, s[12:15], s42 offen offset:0 lds
    buffer_load_dwordx4 v207, s[12:15], s42 offen offset:1024 lds
    s_mul_i32 s95, s29, 663552
    s_add_u32 s16, s98, s95
    s_addc_u32 s17, s99, 0
    s_mov_b32 s18, 663552
    s_mov_b32 s19, 0x20000
    s_mul_i32 s95, s28, 590848
    s_add_u32 s20, s90, s95
    s_addc_u32 s21, s91, 0
    s_mov_b32 s22, 590848
    s_mov_b32 s23, 0x20000
    s_mov_b32 s4, s88
    s_mov_b32 s5, s89
    s_mov_b32 s6, 256
    s_mov_b32 s7, 0x20000
    s_lshl_b32 s100, s100, 4
    s_bitset1_b32 s100, 31
    v_mov_b32 v7, s100
    buffer_store_dword v7, v245, s[4:7], 0 offen sc1
    s_mul_i32 s95, s28, 73728
    s_add_u32 s100, s86, s95
    s_addc_u32 s101, s87, 0
    s_waitcnt vmcnt(25)
    s_mov_b32 s24, s84
    s_mov_b32 s25, s85
    s_mov_b32 s26, 1152
    s_mov_b32 s27, 0x20000
    v_lshlrev_b32 v8, 16, v224
    v_and_b32 v9, 0xffff0000, v224
    v_lshlrev_b32 v10, 16, v225
    v_and_b32 v11, 0xffff0000, v225
    ds_write_b128 v227, v[8:11]
    s_mov_b64 vcc, -1
    s_cmp_eq_u32 s30, 0
    s_cbranch_scc1 L_pg0
    s_cmp_eq_u32 s30, 1
    s_cbranch_scc1 L_pg1
    s_cmp_eq_u32 s30, 2
    s_cbranch_scc1 L_pg2
    s_branch L_pg3
L_walk_done:
    s_mov_b64 vcc, 0
    s_waitcnt vmcnt(19)
    s_waitcnt lgkmcnt(0)
    s_barrier
    ds_read_b128 a[0:3], v214 offset:0
    s_add_u32 m0, s31, 98304
    s_nop 0
    buffer_load_dwordx4 v206, s[12:15], s43 offen offset:0 lds
    ds_read_b128 a[4:7], v214 offset:2048
    ds_read_b128 a[8:11], v214 offset:4096
    ds_read_b128 a[12:15], v214 offset:6144
    ds_read_b128 a[16:19], v215 offset:0
    buffer_load_dwordx4 v207, s[12:15], s43 offen offset:1024 lds
    ds_read_b128 a[20:23], v215 offset:2048
    ds_read_b128 a[24:27], v215 offset:4096
    ds_read_b128 a[28:31], v215 offset:6144
    ds_read_b128 a[32:35], v214 offset:8192
    s_add_u32 m0, s31, 106496
    s_nop 0
    buffer_load_dwordx4 v206, s[12:15], s44 offen offset:0 lds
    ds_read_b128 a[36:39], v214 offset:10240
    ds_read_b128 a[40:43], v214 offset:12288
    ds_read_b128 a[44:47], v214 offset:14336
    ds_read_b128 a[48:51], v215 offset:8192
    buffer_load_dwordx4 v207, s[12:15], s44 offen offset:1024 lds
    s_waitcnt lgkmcnt(6)
    ds_read_b128 a[52:55], v215 offset:10240
    ds_read_b128 a[56:59], v215 offset:12288
    ds_read_b128 a[60:63], v215 offset:14336
    ds_read_b128 a[64:67], v214 offset:16384
    s_add_u32 m0, s31, 114688
    s_nop 0
    buffer_load_dwordx4 v206, s[12:15], s45 offen offset:0 lds
    ds_read_b128 a[68:71], v214 offset:18432
    ds_read_b128 a[72:75], v214 offset:20480
    ds_read_b128 a[76:79], v214 offset:22528
    s_waitcnt lgkmcnt(6)
    ds_read_b128 a[80:83], v215 offset:16384
    buffer_load_dwordx4 v207, s[12:15], s45 offen offset:1024 lds
    ds_read_b128 a[84:87], v215 offset:18432
    ds_read_b128 a[88:91], v215 offset:20480
    ds_read_b128 a[92:95], v215 offset:22528
    s_waitcnt vmcnt(19)
    s_waitcnt lgkmcnt(0)
    s_barrier
    ds_read_b128 a[96:99], v214 offset:24576
    s_add_u32 m0, s31, 122880
    s_nop 0
    buffer_load_dwordx4 v206, s[12:15], s46 offen offset:0 lds
    ds_read_b128 a[100:103], v214 offset:26624
    ds_read_b128 a[104:107], v214 offset:28672
    ds_read_b128 a[108:111], v214 offset:30720
    ds_read_b128 a[112:115], v215 offset:24576
    buffer_load_dwordx4 v207, s[12:15], s46 offen offset:1024 lds
    ds_read_b128 a[116:119], v215 offset:26624
    ds_read_b128 a[120:123], v215 offset:28672
    ds_read_b128 a[124:127], v215 offset:30720
    ds_read_b128 a[128:131], v216 offset:0
    s_add_u32 m0, s31, 131072
    s_nop 0
    buffer_load_dwordx4 v206, s[12:15], s47 offen offset:0 lds
    ds_read_b128 a[132:135], v216 offset:2048
    ds_read_b128 a[136:139], v216 offset:4096
    ds_read_b128 a[140:143], v216 offset:6144
    ds_read_b128 a[144:147], v217 offset:0
    buffer_load_dwordx4 v207, s[12:15], s47 offen offset:1024 lds
    s_waitcnt lgkmcnt(6)
    ds_read_b128 a[148:151], v217 offset:2048
    ds_read_b128 a[152:155], v217 offset:4096
    ds_read_b128 a[156:159], v217 offset:6144
    ds_read_b128 a[160:163], v216 offset:8192
    s_add_u32 m0, s31, 139264
    s_nop 0
    buffer_load_dwordx4 v206, s[12:15], s48 offen offset:0 lds
    ds_read_b128 a[164:167], v216 offset:10240
    ds_read_b128 a[168:171], v216 offset:12288
    ds_read_b128 a[172:175], v216 offset:14336
    s_waitcnt lgkmcnt(6)
    ds_read_b128 a[176:179], v217 offset:8192
    buffer_load_dwordx4 v207, s[12:15], s48 offen offset:1024 lds
    ds_read_b128 a[180:183], v217 offset:10240
    ds_read_b128 a[184:187], v217 offset:12288
    ds_read_b128 a[188:191], v217 offset:14336
    s_waitcnt vmcnt(19)
    s_waitcnt lgkmcnt(0)
    s_barrier
    ds_read_b128 a[192:195], v216 offset:16384
    ds_read_b128 a[196:199], v216 offset:18432
    ds_read_b128 a[200:203], v216 offset:20480
    ds_read_b128 a[204:207], v216 offset:22528
    ds_read_b128 a[208:211], v217 offset:16384
    ds_read_b128 a[212:215], v217 offset:18432
    ds_read_b128 a[216:219], v217 offset:20480
    ds_read_b128 a[220:223], v217 offset:22528
    ds_read_b128 a[224:227], v216 offset:24576
    ds_read_b128 a[228:231], v216 offset:26624
    ds_read_b128 a[232:235], v216 offset:28672
    ds_read_b128 a[236:239], v216 offset:30720
    ds_read_b128 a[240:243], v217 offset:24576
    s_waitcnt lgkmcnt(6)
    ds_read_b128 a[244:247], v217 offset:26624
    ds_read_b128 a[248:251], v217 offset:28672
    ds_read_b128 a[252:255], v217 offset:30720
    ds_read_b128 v[164:167], v216 offset:32768
    ds_read_b128 v[168:171], v216 offset:34816
    ds_read_b128 v[172:175], v216 offset:36864
    ds_read_b128 v[176:179], v216 offset:38912
    s_waitcnt lgkmcnt(6)
    ds_read_b128 v[180:183], v217 offset:32768
    ds_read_b128 v[184:187], v217 offset:34816
    ds_read_b128 v[188:191], v217 offset:36864
    ds_read_b128 v[192:195], v217 offset:38912
    ds_read_b128 v[80:83], v220 offset:0
    s_waitcnt lgkmcnt(0)
    s_waitcnt vmcnt(6)
    s_barrier
    s_branch L_main
.p2align 12
L_main:
L_pg0:
    s_cbranch_vccnz L_pg4
    ds_read_b64_tr_b16 v[48:49], v198 offset:8192
    ds_read_b64_tr_b16 v[50:51], v199 offset:8192
    ds_read_b64_tr_b16 v[52:53], v198 offset:12288
    ds_read_b64_tr_b16 v[54:55], v199 offset:12288
    ds_read_b64_tr_b16 v[56:57], v198 offset:16384
    ds_read_b64_tr_b16 v[58:59], v199 offset:16384
    ds_read_b64_tr_b16 v[60:61], v198 offset:20480
    ds_read_b64_tr_b16 v[62:63], v199 offset:20480
L_pg1:
    s_cbranch_vccnz L_pg5
    ds_read_b64_tr_b16 v[64:65], v198 offset:24576
    ds_read_b64_tr_b16 v[66:67], v199 offset:24576
    s_waitcnt lgkmcnt(8)
    v_mfma_f32_16x16x32_bf16 v[16:19], v[48:51], a[0:3], v[80:83]
    ds_read_b64_tr_b16 v[68:69], v198 offset:28672
    v_add_u32 v206, s59, v208
    v_mfma_f32_16x16x32_bf16 v[20:23], v[48:51], a[4:7], v[80:83]
    ds_read_b64_tr_b16 v[70:71], v199 offset:28672
L_pg2:
    s_cbranch_vccnz L_pg6
    v_add_u32 v207, s59, v209
    v_mfma_f32_16x16x32_bf16 v[24:27], v[48:51], a[8:11], v[80:83]
    s_add_u32 m0, s31, 0
    s_nop 0
    buffer_load_dwordx4 v206, s[12:15], s40 offen offset:0 lds
    v_mfma_f32_16x16x32_bf16 v[28:31], v[48:51], a[12:15], v[80:83]
    buffer_load_dwordx4 v207, s[12:15], s40 offen offset:1024 lds
    s_waitcnt lgkmcnt(8)
    v_mfma_f32_16x16x32_bf16 v[16:19], v[52:55], a[16:19], v[16:19]
    ds_read_b64_tr_b16 v[72:73], v198 offset:32768
    s_add_u32 m0, s31, 8192
    v_mfma_f32_16x16x32_bf16 v[20:23], v[52:55], a[20:23], v[20:23]
    ds_read_b64_tr_b16 v[74:75], v199 offset:32768
    buffer_load_dwordx4 v206, s[12:15], s41 offen offset:0 lds
    v_mfma_f32_16x16x32_bf16 v[24:27], v[52:55], a[24:27], v[24:27]
    v_mfma_f32_16x16x32_bf16 v[28:31], v[52:55], a[28:31], v[28:31]
    buffer_load_dwordx4 v207, s[12:15], s41 offen offset:1024 lds
    s_waitcnt lgkmcnt(8)
    v_mfma_f32_16x16x32_bf16 v[16:19], v[56:59], a[32:35], v[16:19]
    ds_read_b64_tr_b16 v[76:77], v198 offset:36864
    s_add_u32 m0, s31, 16384
    v_mfma_f32_16x16x32_bf16 v[20:23], v[56:59], a[36:39], v[20:23]
    ds_read_b64_tr_b16 v[78:79], v199 offset:36864
    buffer_load_dwordx4 v206, s[12:15], s42 offen offset:0 lds
    v_mfma_f32_16x16x32_bf16 v[24:27], v[56:59], a[40:43], v[24:27]
    buffer_load_dwordx4 v207, s[12:15], s42 offen offset:1024 lds
    v_mfma_f32_16x16x32_bf16 v[28:31], v[56:59], a[44:47], v[28:31]
    s_add_u32 m0, s31, 24576
    s_waitcnt lgkmcnt(8)
    v_mfma_f32_16x16x32_bf16 v[16:19], v[60:63], a[48:51], v[16:19]
    ds_read_b64_tr_b16 v[48:49], v198 offset:40960
    buffer_load_dwordx4 v206, s[12:15], s43 offen offset:0 lds
    v_mfma_f32_16x16x32_bf16 v[20:23], v[60:63], a[52:55], v[20:23]
    ds_read_b64_tr_b16 v[50:51], v199 offset:40960
    v_mfma_f32_16x16x32_bf16 v[24:27], v[60:63], a[56:59], v[24:27]
    buffer_load_dwordx4 v207, s[12:15], s43 offen offset:1024 lds
    s_add_u32 m0, s31, 32768
    v_mfma_f32_16x16x32_bf16 v[28:31], v[60:63], a[60:63], v[28:31]
    buffer_load_dwordx4 v206, s[12:15], s44 offen offset:0 lds
    s_waitcnt lgkmcnt(8)
    v_mfma_f32_16x16x32_bf16 v[16:19], v[64:67], a[64:67], v[16:19]
    ds_read_b64_tr_b16 v[52:53], v198 offset:45056
    v_mfma_f32_16x16x32_bf16 v[20:23], v[64:67], a[68:71], v[20:23]
    ds_read_b64_tr_b16 v[54:55], v199 offset:45056
    buffer_load_dwordx4 v207, s[12:15], s44 offen offset:1024 lds
    v_mfma_f32_16x16x32_bf16 v[24:27], v[64:67], a[72:75], v[24:27]
    s_add_u32 m0, s31, 40960
    v_mfma_f32_16x16x32_bf16 v[28:31], v[64:67], a[76:79], v[28:31]
    buffer_load_dwordx4 v206, s[12:15], s45 offen offset:0 lds
    s_waitcnt lgkmcnt(8)
    v_mfma_f32_16x16x32_bf16 v[16:19], v[68:71], a[80:83], v[16:19]
    ds_read_b64_tr_b16 v[56:57], v198 offset:49152
    v_mfma_f32_16x16x32_bf16 v[20:23], v[68:71], a[84:87], v[20:23]
    ds_read_b64_tr_b16 v[58:59], v199 offset:49152
    buffer_load_dwordx4 v207, s[12:15], s45 offen offset:1024 lds
    v_mfma_f32_16x16x32_bf16 v[24:27], v[68:71], a[88:91], v[24:27]
    v_mfma_f32_16x16x32_bf16 v[28:31], v[68:71], a[92:95], v[28:31]
    s_waitcnt vmcnt(12)
    s_barrier
    s_waitcnt lgkmcnt(8)
    v_mfma_f32_16x16x32_bf16 v[16:19], v[72:75], a[96:99], v[16:19]
    ds_read_b64_tr_b16 v[60:61], v198 offset:53248
    v_mfma_f32_16x16x32_bf16 v[20:23], v[72:75], a[100:103], v[20:23]
    ds_read_b64_tr_b16 v[62:63], v199 offset:53248
    s_add_u32 m0, s31, 49152
    v_mfma_f32_16x16x32_bf16 v[24:27], v[72:75], a[104:107], v[24:27]
    buffer_load_dwordx4 v206, s[12:15], s46 offen offset:0 lds
    v_mfma_f32_16x16x32_bf16 v[28:31], v[72:75], a[108:111], v[28:31]
    s_waitcnt lgkmcnt(8)
    v_mfma_f32_16x16x32_bf16 v[16:19], v[76:79], a[112:115], v[16:19]
    ds_read_b64_tr_b16 v[64:65], v198 offset:57344
    v_mfma_f32_16x16x32_bf16 v[20:23], v[76:79], a[116:119], v[20:23]
    ds_read_b64_tr_b16 v[66:67], v199 offset:57344
    buffer_load_dwordx4 v207, s[12:15], s46 offen offset:1024 lds
    v_mfma_f32_16x16x32_bf16 v[24:27], v[76:79], a[120:123], v[24:27]
    ds_read_b128 v[80:83], v220 offset:256
    v_mfma_f32_16x16x32_bf16 v[28:31], v[76:79], a[124:127], v[28:31]
    s_waitcnt lgkmcnt(9)
    v_mfma_f32_16x16x32_bf16 v[16:19], v[48:51], a[128:131], v[16:19]
    ds_read_b64_tr_b16 v[68:69], v198 offset:61440
    s_add_u32 m0, s31, 57344
    v_mfma_f32_16x16x32_bf16 v[20:23], v[48:51], a[132:135], v[20:23]
    ds_read_b64_tr_b16 v[70:71], v199 offset:61440
    buffer_load_dwordx4 v206, s[12:15], s47 offen offset:0 lds
    v_mfma_f32_16x16x32_bf16 v[24:27], v[48:51], a[136:139], v[24:27]
    v_mfma_f32_16x16x32_bf16 v[28:31], v[48:51], a[140:143], v[28:31]
    s_waitcnt lgkmcnt(9)
    v_mfma_f32_16x16x32_bf16 v[16:19], v[52:55], a[144:147], v[16:19]
    ds_read_b64_tr_b16 v[72:73], v200 offset:0
    v_mfma_f32_16x16x32_bf16 v[20:23], v[52:55], a[148:151], v[20:23]
    ds_read_b64_tr_b16 v[74:75], v201 offset:0
    buffer_load_dwordx4 v207, s[12:15], s47 offen offset:1024 lds
    v_mfma_f32_16x16x32_bf16 v[24:27], v[52:55], a[152:155], v[24:27]
    v_mfma_f32_16x16x32_bf16 v[28:31], v[52:55], a[156:159], v[28:31]
    s_waitcnt lgkmcnt(9)
    v_mfma_f32_16x16x32_bf16 v[16:19], v[56:59], a[160:163], v[16:19]
    ds_read_b64_tr_b16 v[76:77], v200 offset:4096
    s_add_u32 m0, s31, 65536
    v_mfma_f32_16x16x32_bf16 v[20:23], v[56:59], a[164:167], v[20:23]
    ds_read_b64_tr_b16 v[78:79], v201 offset:4096
    buffer_load_dwordx4 v206, s[12:15], s48 offen offset:0 lds
    v_mfma_f32_16x16x32_bf16 v[24:27], v[56:59], a[168:171], v[24:27]
    v_mfma_f32_16x16x32_bf16 v[28:31], v[56:59], a[172:175], v[28:31]
    s_waitcnt lgkmcnt(9)
    v_mfma_f32_16x16x32_bf16 v[16:19], v[60:63], a[176:179], v[16:19]
    ds_read_b64_tr_b16 v[48:49], v200 offset:8192
    v_mfma_f32_16x16x32_bf16 v[20:23], v[60:63], a[180:183], v[20:23]
    ds_read_b64_tr_b16 v[50:51], v201 offset:8192
    buffer_load_dwordx4 v207, s[12:15], s48 offen offset:1024 lds
    v_mfma_f32_16x16x32_bf16 v[24:27], v[60:63], a[184:187], v[24:27]
    v_mfma_f32_16x16x32_bf16 v[28:31], v[60:63], a[188:191], v[28:31]
    s_waitcnt vmcnt(12)
    s_barrier
    s_waitcnt lgkmcnt(9)
    v_mfma_f32_16x16x32_bf16 v[16:19], v[64:67], a[192:195], v[16:19]
    ds_read_b64_tr_b16 v[52:53], v200 offset:12288
    v_add_u32 v206, s60, v208
    v_mfma_f32_16x16x32_bf16 v[20:23], v[64:67], a[196:199], v[20:23]
    ds_read_b64_tr_b16 v[54:55], v201 offset:12288
    v_add_u32 v207, s60, v209
    v_mfma_f32_16x16x32_bf16 v[24:27], v[64:67], a[200:203], v[24:27]
    s_add_u32 m0, s31, 73728
    s_nop 0
    buffer_load_dwordx4 v206, s[12:15], s40 offen offset:0 lds
    v_mfma_f32_16x16x32_bf16 v[28:31], v[64:67], a[204:207], v[28:31]
    s_waitcnt lgkmcnt(8)
    v_mfma_f32_16x16x32_bf16 v[16:19], v[68:71], a[208:211], v[16:19]
    ds_read_b64_tr_b16 v[56:57], v196 offset:0
    v_mfma_f32_16x16x32_bf16 v[20:23], v[68:71], a[212:215], v[20:23]
    ds_read_b64_tr_b16 v[58:59], v197 offset:0
    buffer_load_dwordx4 v207, s[12:15], s40 offen offset:1024 lds
    v_mfma_f32_16x16x32_bf16 v[24:27], v[68:71], a[216:219], v[24:27]
    v_mfma_f32_16x16x32_bf16 v[28:31], v[68:71], a[220:223], v[28:31]
    s_waitcnt lgkmcnt(8)
    v_mfma_f32_16x16x32_bf16 v[16:19], v[72:75], a[224:227], v[16:19]
    ds_read_b64_tr_b16 v[60:61], v196 offset:4096
    s_add_u32 m0, s31, 81920
    v_mfma_f32_16x16x32_bf16 v[20:23], v[72:75], a[228:231], v[20:23]
    ds_read_b64_tr_b16 v[62:63], v197 offset:4096
    buffer_load_dwordx4 v206, s[12:15], s41 offen offset:0 lds
    v_mfma_f32_16x16x32_bf16 v[24:27], v[72:75], a[232:235], v[24:27]
    v_mfma_f32_16x16x32_bf16 v[28:31], v[72:75], a[236:239], v[28:31]
    s_waitcnt lgkmcnt(8)
    v_mfma_f32_16x16x32_bf16 v[16:19], v[76:79], a[240:243], v[16:19]
    ds_read_b64_tr_b16 v[64:65], v196 offset:8192
    v_mfma_f32_16x16x32_bf16 v[20:23], v[76:79], a[244:247], v[20:23]
    ds_read_b64_tr_b16 v[66:67], v197 offset:8192
    buffer_load_dwordx4 v207, s[12:15], s41 offen offset:1024 lds
    v_mfma_f32_16x16x32_bf16 v[24:27], v[76:79], a[248:251], v[24:27]
    v_mfma_f32_16x16x32_bf16 v[28:31], v[76:79], a[252:255], v[28:31]
    s_waitcnt lgkmcnt(8)
    v_mfma_f32_16x16x32_bf16 v[16:19], v[48:51], v[164:167], v[16:19]
    ds_read_b64_tr_b16 v[68:69], v196 offset:12288
    s_add_u32 m0, s31, 90112
    v_mfma_f32_16x16x32_bf16 v[20:23], v[48:51], v[168:171], v[20:23]
    ds_read_b64_tr_b16 v[70:71], v197 offset:12288
    buffer_load_dwordx4 v206, s[12:15], s42 offen offset:0 lds
    v_mfma_f32_16x16x32_bf16 v[24:27], v[48:51], v[172:175], v[24:27]
    v_mfma_f32_16x16x32_bf16 v[28:31], v[48:51], v[176:179], v[28:31]
    s_waitcnt lgkmcnt(8)
    v_mfma_f32_16x16x32_bf16 v[16:19], v[52:55], v[180:183], v[16:19]
    ds_read_b64_tr_b16 v[72:73], v196 offset:16384
    v_mfma_f32_16x16x32_bf16 v[20:23], v[52:55], v[184:187], v[20:23]
    ds_read_b64_tr_b16 v[74:75], v197 offset:16384
    buffer_load_dwordx4 v207, s[12:15], s42 offen offset:1024 lds
    v_mfma_f32_16x16x32_bf16 v[24:27], v[52:55], v[188:191], v[24:27]
    v_mfma_f32_16x16x32_bf16 v[28:31], v[52:55], v[192:195], v[28:31]
    s_waitcnt vmcnt(12)
    s_barrier
    s_waitcnt lgkmcnt(8)
    v_mfma_f32_16x16x32_bf16 v[32:35], v[56:59], a[0:3], v[80:83]
    ds_read_b64_tr_b16 v[76:77], v196 offset:20480
    v_mfma_f32_16x16x32_bf16 v[36:39], v[56:59], a[4:7], v[80:83]
    ds_read_b64_tr_b16 v[78:79], v197 offset:20480
    s_add_u32 m0, s31, 98304
    v_mfma_f32_16x16x32_bf16 v[40:43], v[56:59], a[8:11], v[80:83]
    s_mov_b32 s8, s100
    buffer_load_dwordx4 v206, s[12:15], s43 offen offset:0 lds
    v_mfma_f32_16x16x32_bf16 v[44:47], v[56:59], a[12:15], v[80:83]
    s_mov_b32 s9, s101
    s_waitcnt lgkmcnt(8)
    v_mfma_f32_16x16x32_bf16 v[32:35], v[60:63], a[16:19], v[32:35]
    ds_read_b64_tr_b16 v[48:49], v196 offset:24576
    v_mul_f32_e64 v16, v16, |v16|
    v_mfma_f32_16x16x32_bf16 v[36:39], v[60:63], a[20:23], v[36:39]
    ds_read_b64_tr_b16 v[50:51], v197 offset:24576
    buffer_load_dwordx4 v207, s[12:15], s43 offen offset:1024 lds
    v_mfma_f32_16x16x32_bf16 v[40:43], v[60:63], a[24:27], v[40:43]
    v_mul_f32_e64 v17, v17, |v17|
    v_mfma_f32_16x16x32_bf16 v[44:47], v[60:63], a[28:31], v[44:47]
    v_cvt_pk_bf16_f32 v92, v16, v17
    s_waitcnt lgkmcnt(8)
    v_mfma_f32_16x16x32_bf16 v[32:35], v[64:67], a[32:35], v[32:35]
    ds_read_b64_tr_b16 v[52:53], v196 offset:28672
    s_add_u32 m0, s31, 106496
    v_mfma_f32_16x16x32_bf16 v[36:39], v[64:67], a[36:39], v[36:39]
    ds_read_b64_tr_b16 v[54:55], v197 offset:28672
    v_pk_max_i16 v92, v92, 0
    v_mfma_f32_16x16x32_bf16 v[40:43], v[64:67], a[40:43], v[40:43]
    buffer_load_dwordx4 v206, s[12:15], s44 offen offset:0 lds
    v_mul_f32_e64 v18, v18, |v18|
    v_mfma_f32_16x16x32_bf16 v[44:47], v[64:67], a[44:47], v[44:47]
    s_waitcnt lgkmcnt(8)
    v_mfma_f32_16x16x32_bf16 v[32:35], v[68:71], a[48:51], v[32:35]
    ds_read_b64_tr_b16 v[56:57], v196 offset:32768
    v_mul_f32_e64 v19, v19, |v19|
    v_mfma_f32_16x16x32_bf16 v[36:39], v[68:71], a[52:55], v[36:39]
    ds_read_b64_tr_b16 v[58:59], v197 offset:32768
    buffer_load_dwordx4 v207, s[12:15], s44 offen offset:1024 lds
    v_mfma_f32_16x16x32_bf16 v[40:43], v[68:71], a[56:59], v[40:43]
    v_cvt_pk_bf16_f32 v93, v18, v19
    v_mfma_f32_16x16x32_bf16 v[44:47], v[68:71], a[60:63], v[44:47]
    v_pk_max_i16 v93, v93, 0
    s_waitcnt lgkmcnt(8)
    v_mfma_f32_16x16x32_bf16 v[32:35], v[72:75], a[64:67], v[32:35]
    ds_read_b64_tr_b16 v[60:61], v196 offset:36864
    s_add_u32 m0, s31, 114688
    v_mfma_f32_16x16x32_bf16 v[36:39], v[72:75], a[68:71], v[36:39]
    ds_read_b64_tr_b16 v[62:63], v197 offset:36864
    buffer_load_dwordx4 v206, s[12:15], s45 offen offset:0 lds
    v_mfma_f32_16x16x32_bf16 v[40:43], v[72:75], a[72:75], v[40:43]
    v_mul_f32_e64 v20, v20, |v20|
    v_mul_f32_e64 v21, v21, |v21|
    v_mfma_f32_16x16x32_bf16 v[44:47], v[72:75], a[76:79], v[44:47]
    s_waitcnt lgkmcnt(8)
    v_mfma_f32_16x16x32_bf16 v[32:35], v[76:79], a[80:83], v[32:35]
    ds_read_b64_tr_b16 v[64:65], v196 offset:40960
    v_cvt_pk_bf16_f32 v96, v20, v21
    v_mfma_f32_16x16x32_bf16 v[36:39], v[76:79], a[84:87], v[36:39]
    ds_read_b64_tr_b16 v[66:67], v197 offset:40960
    buffer_load_dwordx4 v207, s[12:15], s45 offen offset:1024 lds
    v_mfma_f32_16x16x32_bf16 v[40:43], v[76:79], a[88:91], v[40:43]
    v_pk_max_i16 v96, v96, 0
    v_mfma_f32_16x16x32_bf16 v[44:47], v[76:79], a[92:95], v[44:47]
    v_mul_f32_e64 v22, v22, |v22|
    s_waitcnt vmcnt(12)
    s_barrier
    s_waitcnt lgkmcnt(8)
    v_mfma_f32_16x16x32_bf16 v[32:35], v[48:51], a[96:99], v[32:35]
    ds_read_b64_tr_b16 v[68:69], v196 offset:45056
    v_mfma_f32_16x16x32_bf16 v[36:39], v[48:51], a[100:103], v[36:39]
    ds_read_b64_tr_b16 v[70:71], v197 offset:45056
    s_add_u32 m0, s31, 122880
    v_mfma_f32_16x16x32_bf16 v[40:43], v[48:51], a[104:107], v[40:43]
    v_mul_f32_e64 v23, v23, |v23|
    buffer_load_dwordx4 v206, s[12:15], s46 offen offset:0 lds
    v_mfma_f32_16x16x32_bf16 v[44:47], v[48:51], a[108:111], v[44:47]
    v_cvt_pk_bf16_f32 v97, v22, v23
    s_waitcnt lgkmcnt(8)
    v_mfma_f32_16x16x32_bf16 v[32:35], v[52:55], a[112:115], v[32:35]
    ds_read_b64_tr_b16 v[72:73], v196 offset:49152
    v_pk_max_i16 v97, v97, 0
    v_mfma_f32_16x16x32_bf16 v[36:39], v[52:55], a[116:119], v[36:39]
    ds_read_b64_tr_b16 v[74:75], v197 offset:49152
    buffer_load_dwordx4 v207, s[12:15], s46 offen offset:1024 lds
    v_mfma_f32_16x16x32_bf16 v[40:43], v[52:55], a[120:123], v[40:43]
    v_mul_f32_e64 v24, v24, |v24|
    ds_read_b128 v[80:83], v220 offset:512
    v_mfma_f32_16x16x32_bf16 v[44:47], v[52:55], a[124:127], v[44:47]
    v_mul_f32_e64 v25, v25, |v25|
    s_waitcnt lgkmcnt(9)
    v_mfma_f32_16x16x32_bf16 v[32:35], v[56:59], a[128:131], v[32:35]
    ds_read_b64_tr_b16 v[76:77], v196 offset:53248
    s_add_u32 m0, s31, 131072
    v_mfma_f32_16x16x32_bf16 v[36:39], v[56:59], a[132:135], v[36:39]
    ds_read_b64_tr_b16 v[78:79], v197 offset:53248
    buffer_load_dwordx4 v206, s[12:15], s47 offen offset:0 lds
    v_mfma_f32_16x16x32_bf16 v[40:43], v[56:59], a[136:139], v[40:43]
    v_cvt_pk_bf16_f32 v100, v24, v25
    v_pk_max_i16 v100, v100, 0
    v_mfma_f32_16x16x32_bf16 v[44:47], v[56:59], a[140:143], v[44:47]
    s_waitcnt lgkmcnt(9)
    v_mfma_f32_16x16x32_bf16 v[32:35], v[60:63], a[144:147], v[32:35]
    ds_read_b64_tr_b16 v[48:49], v196 offset:57344
    v_mul_f32_e64 v26, v26, |v26|
    v_mfma_f32_16x16x32_bf16 v[36:39], v[60:63], a[148:151], v[36:39]
    ds_read_b64_tr_b16 v[50:51], v197 offset:57344
    buffer_load_dwordx4 v207, s[12:15], s47 offen offset:1024 lds
    v_mfma_f32_16x16x32_bf16 v[40:43], v[60:63], a[152:155], v[40:43]
    v_mul_f32_e64 v27, v27, |v27|
    v_mfma_f32_16x16x32_bf16 v[44:47], v[60:63], a[156:159], v[44:47]
    v_cvt_pk_bf16_f32 v101, v26, v27
    s_waitcnt lgkmcnt(9)
    v_mfma_f32_16x16x32_bf16 v[32:35], v[64:67], a[160:163], v[32:35]
    ds_read_b64_tr_b16 v[52:53], v196 offset:61440
    s_add_u32 m0, s31, 139264
    v_mfma_f32_16x16x32_bf16 v[36:39], v[64:67], a[164:167], v[36:39]
    ds_read_b64_tr_b16 v[54:55], v197 offset:61440
    buffer_load_dwordx4 v206, s[12:15], s48 offen offset:0 lds
    v_mfma_f32_16x16x32_bf16 v[40:43], v[64:67], a[168:171], v[40:43]
    v_pk_max_i16 v101, v101, 0
    v_mfma_f32_16x16x32_bf16 v[44:47], v[64:67], a[172:175], v[44:47]
    v_mul_f32_e64 v28, v28, |v28|
    s_waitcnt lgkmcnt(9)
    v_mfma_f32_16x16x32_bf16 v[32:35], v[68:71], a[176:179], v[32:35]
    ds_read_b64_tr_b16 v[56:57], v198 offset:0
    v_mul_f32_e64 v29, v29, |v29|
    v_mfma_f32_16x16x32_bf16 v[36:39], v[68:71], a[180:183], v[36:39]
    ds_read_b64_tr_b16 v[58:59], v199 offset:0
    buffer_load_dwordx4 v207, s[12:15], s48 offen offset:1024 lds
    v_mfma_f32_16x16x32_bf16 v[40:43], v[68:71], a[184:187], v[40:43]
    v_cvt_pk_bf16_f32 v104, v28, v29
    v_mfma_f32_16x16x32_bf16 v[44:47], v[68:71], a[188:191], v[44:47]
    v_pk_max_i16 v104, v104, 0
    s_waitcnt vmcnt(12)
    s_barrier
    s_waitcnt lgkmcnt(9)
    v_mfma_f32_16x16x32_bf16 v[32:35], v[72:75], a[192:195], v[32:35]
    ds_read_b64_tr_b16 v[60:61], v198 offset:4096
    v_add_u32 v206, s61, v208
    v_mfma_f32_16x16x32_bf16 v[36:39], v[72:75], a[196:199], v[36:39]
    ds_read_b64_tr_b16 v[62:63], v199 offset:4096
    v_add_u32 v207, s61, v209
    v_mfma_f32_16x16x32_bf16 v[40:43], v[72:75], a[200:203], v[40:43]
    s_add_u32 m0, s31, 0
    v_mul_f32_e64 v30, v30, |v30|
    v_mfma_f32_16x16x32_bf16 v[44:47], v[72:75], a[204:207], v[44:47]
    buffer_load_dwordx4 v206, s[12:15], s40 offen offset:0 lds
    s_waitcnt lgkmcnt(8)
    v_mfma_f32_16x16x32_bf16 v[32:35], v[76:79], a[208:211], v[32:35]
    ds_read_b64_tr_b16 v[64:65], v198 offset:8192
    v_mul_f32_e64 v31, v31, |v31|
    v_mfma_f32_16x16x32_bf16 v[36:39], v[76:79], a[212:215], v[36:39]
    ds_read_b64_tr_b16 v[66:67], v199 offset:8192
    v_cvt_pk_bf16_f32 v105, v30, v31
    v_mfma_f32_16x16x32_bf16 v[40:43], v[76:79], a[216:219], v[40:43]
    buffer_load_dwordx4 v207, s[12:15], s40 offen offset:1024 lds
    v_pk_max_i16 v105, v105, 0
    v_mfma_f32_16x16x32_bf16 v[44:47], v[76:79], a[220:223], v[44:47]
    s_waitcnt lgkmcnt(8)
    v_mfma_f32_16x16x32_bf16 v[32:35], v[48:51], a[224:227], v[32:35]
    ds_read_b64_tr_b16 v[68:69], v198 offset:12288
    s_add_u32 m0, s31, 8192
    v_mfma_f32_16x16x32_bf16 v[36:39], v[48:51], a[228:231], v[36:39]
    ds_read_b64_tr_b16 v[70:71], v199 offset:12288
    buffer_load_dwordx4 v206, s[12:15], s41 offen offset:0 lds
    v_mfma_f32_16x16x32_bf16 v[40:43], v[48:51], a[232:235], v[40:43]
    v_mfma_f32_16x16x32_bf16 v[44:47], v[48:51], a[236:239], v[44:47]
    s_waitcnt lgkmcnt(8)
    v_mfma_f32_16x16x32_bf16 v[32:35], v[52:55], a[240:243], v[32:35]
    ds_read_b64_tr_b16 v[72:73], v198 offset:16384
    v_mfma_f32_16x16x32_bf16 v[36:39], v[52:55], a[244:247], v[36:39]
    ds_read_b64_tr_b16 v[74:75], v199 offset:16384
    buffer_load_dwordx4 v207, s[12:15], s41 offen offset:1024 lds
    v_mfma_f32_16x16x32_bf16 v[40:43], v[52:55], a[248:251], v[40:43]
    v_mfma_f32_16x16x32_bf16 v[44:47], v[52:55], a[252:255], v[44:47]
    s_waitcnt lgkmcnt(8)
    v_mfma_f32_16x16x32_bf16 v[32:35], v[56:59], v[164:167], v[32:35]
    ds_read_b64_tr_b16 v[76:77], v198 offset:20480
    s_add_u32 m0, s31, 16384
    v_mfma_f32_16x16x32_bf16 v[36:39], v[56:59], v[168:171], v[36:39]
    ds_read_b64_tr_b16 v[78:79], v199 offset:20480
    buffer_load_dwordx4 v206, s[12:15], s42 offen offset:0 lds
    v_mfma_f32_16x16x32_bf16 v[40:43], v[56:59], v[172:175], v[40:43]
    v_mfma_f32_16x16x32_bf16 v[44:47], v[56:59], v[176:179], v[44:47]
    s_waitcnt lgkmcnt(8)
    v_mfma_f32_16x16x32_bf16 v[32:35], v[60:63], v[180:183], v[32:35]
    ds_read_b64_tr_b16 v[48:49], v198 offset:24576
    v_mfma_f32_16x16x32_bf16 v[36:39], v[60:63], v[184:187], v[36:39]
    ds_read_b64_tr_b16 v[50:51], v199 offset:24576
    buffer_load_dwordx4 v207, s[12:15], s42 offen offset:1024 lds
    v_mfma_f32_16x16x32_bf16 v[40:43], v[60:63], v[188:191], v[40:43]
    v_mfma_f32_16x16x32_bf16 v[44:47], v[60:63], v[192:195], v[44:47]
    s_waitcnt vmcnt(12)
    s_barrier
    s_waitcnt lgkmcnt(8)
    v_mfma_f32_16x16x32_bf16 v[16:19], v[64:67], a[0:3], v[80:83]
    ds_read_b64_tr_b16 v[52:53], v198 offset:28672
    v_mfma_f32_16x16x32_bf16 v[20:23], v[64:67], a[4:7], v[80:83]
    ds_read_b64_tr_b16 v[54:55], v199 offset:28672
    s_add_u32 m0, s31, 24576
    v_mfma_f32_16x16x32_bf16 v[24:27], v[64:67], a[8:11], v[80:83]
    buffer_load_dwordx4 v206, s[12:15], s43 offen offset:0 lds
    v_mfma_f32_16x16x32_bf16 v[28:31], v[64:67], a[12:15], v[80:83]
    s_waitcnt lgkmcnt(8)
    v_mfma_f32_16x16x32_bf16 v[16:19], v[68:71], a[16:19], v[16:19]
    ds_read_b64_tr_b16 v[56:57], v198 offset:32768
    v_mul_f32_e64 v32, v32, |v32|
    v_mfma_f32_16x16x32_bf16 v[20:23], v[68:71], a[20:23], v[20:23]
    ds_read_b64_tr_b16 v[58:59], v199 offset:32768
    buffer_load_dwordx4 v207, s[12:15], s43 offen offset:1024 lds
    v_mfma_f32_16x16x32_bf16 v[24:27], v[68:71], a[24:27], v[24:27]
    v_mul_f32_e64 v33, v33, |v33|
    v_mfma_f32_16x16x32_bf16 v[28:31], v[68:71], a[28:31], v[28:31]
    v_cvt_pk_bf16_f32 v94, v32, v33
    s_waitcnt lgkmcnt(8)
    v_mfma_f32_16x16x32_bf16 v[16:19], v[72:75], a[32:35], v[16:19]
    ds_read_b64_tr_b16 v[60:61], v198 offset:36864
    s_add_u32 m0, s31, 32768
    v_mfma_f32_16x16x32_bf16 v[20:23], v[72:75], a[36:39], v[20:23]
    ds_read_b64_tr_b16 v[62:63], v199 offset:36864
    v_pk_max_i16 v94, v94, 0
    v_mfma_f32_16x16x32_bf16 v[24:27], v[72:75], a[40:43], v[24:27]
    buffer_load_dwordx4 v206, s[12:15], s44 offen offset:0 lds
    v_mul_f32_e64 v34, v34, |v34|
    v_mfma_f32_16x16x32_bf16 v[28:31], v[72:75], a[44:47], v[28:31]
    s_waitcnt lgkmcnt(8)
    v_mfma_f32_16x16x32_bf16 v[16:19], v[76:79], a[48:51], v[16:19]
    ds_read_b64_tr_b16 v[64:65], v198 offset:40960
    v_mul_f32_e64 v35, v35, |v35|
    v_mfma_f32_16x16x32_bf16 v[20:23], v[76:79], a[52:55], v[20:23]
    ds_read_b64_tr_b16 v[66:67], v199 offset:40960
    buffer_load_dwordx4 v207, s[12:15], s44 offen offset:1024 lds
    v_mfma_f32_16x16x32_bf16 v[24:27], v[76:79], a[56:59], v[24:27]
    v_cvt_pk_bf16_f32 v95, v34, v35
    v_mfma_f32_16x16x32_bf16 v[28:31], v[76:79], a[60:63], v[28:31]
    v_pk_max_i16 v95, v95, 0
    s_waitcnt lgkmcnt(8)
    v_mfma_f32_16x16x32_bf16 v[16:19], v[48:51], a[64:67], v[16:19]
    ds_read_b64_tr_b16 v[68:69], v198 offset:45056
    s_add_u32 m0, s31, 40960
    v_mfma_f32_16x16x32_bf16 v[20:23], v[48:51], a[68:71], v[20:23]
    ds_read_b64_tr_b16 v[70:71], v199 offset:45056
    buffer_load_dwordx4 v206, s[12:15], s45 offen offset:0 lds
    v_mfma_f32_16x16x32_bf16 v[24:27], v[48:51], a[72:75], v[24:27]
    v_mul_f32_e64 v36, v36, |v36|
    v_mul_f32_e64 v37, v37, |v37|
    v_mfma_f32_16x16x32_bf16 v[28:31], v[48:51], a[76:79], v[28:31]
    s_waitcnt lgkmcnt(8)
    v_mfma_f32_16x16x32_bf16 v[16:19], v[52:55], a[80:83], v[16:19]
    ds_read_b64_tr_b16 v[72:73], v198 offset:49152
    v_cvt_pk_bf16_f32 v98, v36, v37
    v_mfma_f32_16x16x32_bf16 v[20:23], v[52:55], a[84:87], v[20:23]
    ds_read_b64_tr_b16 v[74:75], v199 offset:49152
    buffer_load_dwordx4 v207, s[12:15], s45 offen offset:1024 lds
    v_mfma_f32_16x16x32_bf16 v[24:27], v[52:55], a[88:91], v[24:27]
    v_pk_max_i16 v98, v98, 0
    v_mfma_f32_16x16x32_bf16 v[28:31], v[52:55], a[92:95], v[28:31]
    v_mul_f32_e64 v38, v38, |v38|
    s_waitcnt vmcnt(12)
    s_barrier
    s_waitcnt lgkmcnt(8)
    v_mfma_f32_16x16x32_bf16 v[16:19], v[56:59], a[96:99], v[16:19]
    ds_read_b64_tr_b16 v[76:77], v198 offset:53248
    v_mfma_f32_16x16x32_bf16 v[20:23], v[56:59], a[100:103], v[20:23]
    ds_read_b64_tr_b16 v[78:79], v199 offset:53248
    s_add_u32 m0, s31, 49152
    v_mfma_f32_16x16x32_bf16 v[24:27], v[56:59], a[104:107], v[24:27]
    v_mul_f32_e64 v39, v39, |v39|
    buffer_load_dwordx4 v206, s[12:15], s46 offen offset:0 lds
    v_mfma_f32_16x16x32_bf16 v[28:31], v[56:59], a[108:111], v[28:31]
    v_cvt_pk_bf16_f32 v99, v38, v39
    s_waitcnt lgkmcnt(8)
    v_mfma_f32_16x16x32_bf16 v[16:19], v[60:63], a[112:115], v[16:19]
    ds_read_b64_tr_b16 v[48:49], v198 offset:57344
    v_pk_max_i16 v99, v99, 0
    v_mfma_f32_16x16x32_bf16 v[20:23], v[60:63], a[116:119], v[20:23]
    ds_read_b64_tr_b16 v[50:51], v199 offset:57344
    buffer_load_dwordx4 v207, s[12:15], s46 offen offset:1024 lds
    v_mfma_f32_16x16x32_bf16 v[24:27], v[60:63], a[120:123], v[24:27]
    v_mul_f32_e64 v40, v40, |v40|
    ds_read_b128 v[80:83], v220 offset:768
    v_mfma_f32_16x16x32_bf16 v[28:31], v[60:63], a[124:127], v[28:31]
    v_mul_f32_e64 v41, v41, |v41|
    s_waitcnt lgkmcnt(9)
    v_mfma_f32_16x16x32_bf16 v[16:19], v[64:67], a[128:131], v[16:19]
    ds_read_b64_tr_b16 v[52:53], v198 offset:61440
    s_add_u32 m0, s31, 57344
    v_mfma_f32_16x16x32_bf16 v[20:23], v[64:67], a[132:135], v[20:23]
    ds_read_b64_tr_b16 v[54:55], v199 offset:61440
    buffer_load_dwordx4 v206, s[12:15], s47 offen offset:0 lds
    v_mfma_f32_16x16x32_bf16 v[24:27], v[64:67], a[136:139], v[24:27]
    v_cvt_pk_bf16_f32 v102, v40, v41
    v_pk_max_i16 v102, v102, 0
    v_mfma_f32_16x16x32_bf16 v[28:31], v[64:67], a[140:143], v[28:31]
    s_waitcnt lgkmcnt(9)
    v_mfma_f32_16x16x32_bf16 v[16:19], v[68:71], a[144:147], v[16:19]
    ds_read_b64_tr_b16 v[56:57], v200 offset:0
    v_mul_f32_e64 v42, v42, |v42|
    v_mfma_f32_16x16x32_bf16 v[20:23], v[68:71], a[148:151], v[20:23]
    ds_read_b64_tr_b16 v[58:59], v201 offset:0
    buffer_load_dwordx4 v207, s[12:15], s47 offen offset:1024 lds
    v_mfma_f32_16x16x32_bf16 v[24:27], v[68:71], a[152:155], v[24:27]
    v_mul_f32_e64 v43, v43, |v43|
    v_mfma_f32_16x16x32_bf16 v[28:31], v[68:71], a[156:159], v[28:31]
    v_cvt_pk_bf16_f32 v103, v42, v43
    s_waitcnt lgkmcnt(9)
    v_mfma_f32_16x16x32_bf16 v[16:19], v[72:75], a[160:163], v[16:19]
    ds_read_b64_tr_b16 v[60:61], v200 offset:4096
    s_add_u32 m0, s31, 65536
    v_mfma_f32_16x16x32_bf16 v[20:23], v[72:75], a[164:167], v[20:23]
    ds_read_b64_tr_b16 v[62:63], v201 offset:4096
    buffer_load_dwordx4 v206, s[12:15], s48 offen offset:0 lds
    v_mfma_f32_16x16x32_bf16 v[24:27], v[72:75], a[168:171], v[24:27]
    v_pk_max_i16 v103, v103, 0
    v_mfma_f32_16x16x32_bf16 v[28:31], v[72:75], a[172:175], v[28:31]
    v_mul_f32_e64 v44, v44, |v44|
    s_waitcnt lgkmcnt(9)
    v_mfma_f32_16x16x32_bf16 v[16:19], v[76:79], a[176:179], v[16:19]
    ds_read_b64_tr_b16 v[64:65], v200 offset:8192
    v_mul_f32_e64 v45, v45, |v45|
    v_mfma_f32_16x16x32_bf16 v[20:23], v[76:79], a[180:183], v[20:23]
    ds_read_b64_tr_b16 v[66:67], v201 offset:8192
    buffer_load_dwordx4 v207, s[12:15], s48 offen offset:1024 lds
    v_mfma_f32_16x16x32_bf16 v[24:27], v[76:79], a[184:187], v[24:27]
    v_cvt_pk_bf16_f32 v106, v44, v45
    v_mfma_f32_16x16x32_bf16 v[28:31], v[76:79], a[188:191], v[28:31]
    v_pk_max_i16 v106, v106, 0
    s_waitcnt vmcnt(12)
    s_barrier
    s_waitcnt lgkmcnt(9)
    v_mfma_f32_16x16x32_bf16 v[16:19], v[48:51], a[192:195], v[16:19]
    ds_read_b64_tr_b16 v[68:69], v200 offset:12288
    v_add_u32 v206, s62, v208
    v_mfma_f32_16x16x32_bf16 v[20:23], v[48:51], a[196:199], v[20:23]
    ds_read_b64_tr_b16 v[70:71], v201 offset:12288
    v_add_u32 v207, s62, v209
    v_mfma_f32_16x16x32_bf16 v[24:27], v[48:51], a[200:203], v[24:27]
    s_add_u32 s95, s30, 0
    s_and_b32 s95, s95, 3
    s_add_u32 m0, s31, 73728
    v_mfma_f32_16x16x32_bf16 v[28:31], v[48:51], a[204:207], v[28:31]
    v_mul_f32_e64 v46, v46, |v46|
    s_lshl_b32 s95, s95, 11
    s_waitcnt lgkmcnt(8)
    v_mfma_f32_16x16x32_bf16 v[16:19], v[52:55], a[208:211], v[16:19]
    ds_read_b64_tr_b16 v[72:73], v196 offset:0
    buffer_load_dwordx4 v206, s[12:15], s40 offen offset:0 lds
    v_mfma_f32_16x16x32_bf16 v[20:23], v[52:55], a[212:215], v[20:23]
    ds_read_b64_tr_b16 v[74:75], v197 offset:0
    v_add_u32 v214, s95, v202
    v_mfma_f32_16x16x32_bf16 v[24:27], v[52:55], a[216:219], v[24:27]
    v_mul_f32_e64 v47, v47, |v47|
    v_add_u32 v215, s95, v203
    v_cvt_pk_bf16_f32 v107, v46, v47
    v_mfma_f32_16x16x32_bf16 v[28:31], v[52:55], a[220:223], v[28:31]
    v_add_u32 v216, s95, v204
    buffer_load_dwordx4 v207, s[12:15], s40 offen offset:1024 lds
    s_waitcnt lgkmcnt(8)
    v_mfma_f32_16x16x32_bf16 v[16:19], v[56:59], a[224:227], v[16:19]
    ds_read_b64_tr_b16 v[76:77], v196 offset:4096
    v_pk_max_i16 v107, v107, 0
    v_mfma_f32_16x16x32_bf16 v[20:23], v[56:59], a[228:231], v[20:23]
    ds_read_b64_tr_b16 v[78:79], v197 offset:4096
    s_add_u32 s95, s30, 1
    v_mfma_f32_16x16x32_bf16 v[24:27], v[56:59], a[232:235], v[24:27]
    s_and_b32 s95, s95, 3
    s_lshl_b32 s95, s95, 11
    s_add_u32 m0, s31, 81920
    v_mfma_f32_16x16x32_bf16 v[28:31], v[56:59], a[236:239], v[28:31]
L_pg3:
    s_cbranch_vccnz L_pg7
    v_add_u32 v217, s95, v202
    buffer_load_dwordx4 v206, s[12:15], s41 offen offset:0 lds
    s_waitcnt lgkmcnt(8)
    v_mfma_f32_16x16x32_bf16 v[16:19], v[60:63], a[240:243], v[16:19]
    ds_read_b64_tr_b16 v[48:49], v196 offset:8192
    v_add_u32 v222, s95, v203
    v_mfma_f32_16x16x32_bf16 v[20:23], v[60:63], a[244:247], v[20:23]
    ds_read_b64_tr_b16 v[50:51], v197 offset:8192
    v_add_u32 v223, s95, v204
L_pg4:
    s_cbranch_vccnz L_pg8
    v_mfma_f32_16x16x32_bf16 v[24:27], v[60:63], a[248:251], v[24:27]
    s_add_u32 s95, s30, 2
    s_and_b32 s95, s95, 3
    v_mfma_f32_16x16x32_bf16 v[28:31], v[60:63], a[252:255], v[28:31]
    buffer_load_dwordx4 v207, s[12:15], s41 offen offset:1024 lds
    s_lshl_b32 s95, s95, 11
    s_waitcnt lgkmcnt(8)
    v_mfma_f32_16x16x32_bf16 v[16:19], v[64:67], v[164:167], v[16:19]
    ds_read_b64_tr_b16 v[52:53], v196 offset:12288
    v_add_u32 v224, s95, v202
L_pg5:
    s_cbranch_vccnz L_pg9
    v_mfma_f32_16x16x32_bf16 v[20:23], v[64:67], v[168:171], v[20:23]
    ds_read_b64_tr_b16 v[54:55], v197 offset:12288
    v_add_u32 v225, s95, v203
    v_mfma_f32_16x16x32_bf16 v[24:27], v[64:67], v[172:175], v[24:27]
    s_add_u32 m0, s31, 90112
    v_add_u32 v226, s95, v204
    v_mfma_f32_16x16x32_bf16 v[28:31], v[64:67], v[176:179], v[28:31]
    buffer_load_dwordx4 v206, s[12:15], s42 offen offset:0 lds
    s_add_u32 s95, s30, 3
    s_waitcnt lgkmcnt(8)
    v_mfma_f32_16x16x32_bf16 v[16:19], v[68:71], v[180:183], v[16:19]
    ds_read_b64_tr_b16 v[56:57], v196 offset:16384
    s_and_b32 s95, s95, 3
    v_mfma_f32_16x16x32_bf16 v[20:23], v[68:71], v[184:187], v[20:23]
    ds_read_b64_tr_b16 v[58:59], v197 offset:16384
    s_lshl_b32 s95, s95, 11
    v_mfma_f32_16x16x32_bf16 v[24:27], v[68:71], v[188:191], v[24:27]
    v_add_u32 v227, s95, v202
    buffer_load_dwordx4 v207, s[12:15], s42 offen offset:1024 lds
    v_mfma_f32_16x16x32_bf16 v[28:31], v[68:71], v[192:195], v[28:31]
    v_add_u32 v246, s95, v203
    v_add_u32 v247, s95, v204
    s_waitcnt vmcnt(12)
    s_barrier
    s_waitcnt lgkmcnt(8)
    v_mfma_f32_16x16x32_bf16 v[32:35], v[72:75], a[0:3], v[80:83]
    ds_read_b64_tr_b16 v[60:61], v196 offset:20480
    v_mfma_f32_16x16x32_bf16 v[36:39], v[72:75], a[4:7], v[80:83]
    ds_read_b64_tr_b16 v[62:63], v197 offset:20480
    s_add_u32 m0, s31, 98304
    v_mfma_f32_16x16x32_bf16 v[40:43], v[72:75], a[8:11], v[80:83]
    buffer_load_dwordx4 v206, s[12:15], s43 offen offset:0 lds
    v_mfma_f32_16x16x32_bf16 v[44:47], v[72:75], a[12:15], v[80:83]
    s_waitcnt lgkmcnt(8)
    v_mfma_f32_16x16x32_bf16 v[32:35], v[76:79], a[16:19], v[32:35]
    ds_read_b64_tr_b16 v[64:65], v196 offset:24576
    v_mul_f32_e64 v16, v16, |v16|
    v_mfma_f32_16x16x32_bf16 v[36:39], v[76:79], a[20:23], v[36:39]
    ds_read_b64_tr_b16 v[66:67], v197 offset:24576
    buffer_load_dwordx4 v207, s[12:15], s43 offen offset:1024 lds
    v_mfma_f32_16x16x32_bf16 v[40:43], v[76:79], a[24:27], v[40:43]
    v_mul_f32_e64 v17, v17, |v17|
    v_mfma_f32_16x16x32_bf16 v[44:47], v[76:79], a[28:31], v[44:47]
    v_cvt_pk_bf16_f32 v108, v16, v17
    s_waitcnt lgkmcnt(8)
    v_mfma_f32_16x16x32_bf16 v[32:35], v[48:51], a[32:35], v[32:35]
    ds_read_b64_tr_b16 v[68:69], v196 offset:28672
    s_add_u32 m0, s31, 106496
    v_mfma_f32_16x16x32_bf16 v[36:39], v[48:51], a[36:39], v[36:39]
    ds_read_b64_tr_b16 v[70:71], v197 offset:28672
    v_pk_max_i16 v108, v108, 0
    v_mfma_f32_16x16x32_bf16 v[40:43], v[48:51], a[40:43], v[40:43]
    buffer_load_dwordx4 v206, s[12:15], s44 offen offset:0 lds
    v_mul_f32_e64 v18, v18, |v18|
    v_mfma_f32_16x16x32_bf16 v[44:47], v[48:51], a[44:47], v[44:47]
    s_waitcnt lgkmcnt(8)
    v_mfma_f32_16x16x32_bf16 v[32:35], v[52:55], a[48:51], v[32:35]
    ds_read_b64_tr_b16 v[72:73], v196 offset:32768
    v_mul_f32_e64 v19, v19, |v19|
    v_mfma_f32_16x16x32_bf16 v[36:39], v[52:55], a[52:55], v[36:39]
    ds_read_b64_tr_b16 v[74:75], v197 offset:32768
    buffer_load_dwordx4 v207, s[12:15], s44 offen offset:1024 lds
    v_mfma_f32_16x16x32_bf16 v[40:43], v[52:55], a[56:59], v[40:43]
    v_cvt_pk_bf16_f32 v109, v18, v19
    v_mfma_f32_16x16x32_bf16 v[44:47], v[52:55], a[60:63], v[44:47]
    v_pk_max_i16 v109, v109, 0
    s_waitcnt lgkmcnt(8)
    v_mfma_f32_16x16x32_bf16 v[32:35], v[56:59], a[64:67], v[32:35]
    ds_read_b64_tr_b16 v[76:77], v196 offset:36864
    s_add_u32 m0, s31, 114688
    v_mfma_f32_16x16x32_bf16 v[36:39], v[56:59], a[68:71], v[36:39]
    ds_read_b64_tr_b16 v[78:79], v197 offset:36864
    buffer_load_dwordx4 v206, s[12:15], s45 offen offset:0 lds
    v_mfma_f32_16x16x32_bf16 v[40:43], v[56:59], a[72:75], v[40:43]
    v_mul_f32_e64 v20, v20, |v20|
    v_mul_f32_e64 v21, v21, |v21|
    v_mfma_f32_16x16x32_bf16 v[44:47], v[56:59], a[76:79], v[44:47]
    s_waitcnt lgkmcnt(8)
    v_mfma_f32_16x16x32_bf16 v[32:35], v[60:63], a[80:83], v[32:35]
    ds_read_b64_tr_b16 v[48:49], v196 offset:40960
    v_cvt_pk_bf16_f32 v110, v20, v21
    v_mfma_f32_16x16x32_bf16 v[36:39], v[60:63], a[84:87], v[36:39]
    ds_read_b64_tr_b16 v[50:51], v197 offset:40960
    buffer_load_dwordx4 v207, s[12:15], s45 offen offset:1024 lds
    v_mfma_f32_16x16x32_bf16 v[40:43], v[60:63], a[88:91], v[40:43]
    v_pk_max_i16 v110, v110, 0
    v_mfma_f32_16x16x32_bf16 v[44:47], v[60:63], a[92:95], v[44:47]
    v_mul_f32_e64 v22, v22, |v22|
    s_waitcnt vmcnt(12)
    s_barrier
    s_waitcnt lgkmcnt(8)
    v_mfma_f32_16x16x32_bf16 v[32:35], v[64:67], a[96:99], v[32:35]
    ds_read_b64_tr_b16 v[52:53], v196 offset:45056
    v_mfma_f32_16x16x32_bf16 v[36:39], v[64:67], a[100:103], v[36:39]
    ds_read_b64_tr_b16 v[54:55], v197 offset:45056
    s_add_u32 m0, s31, 122880
    v_mfma_f32_16x16x32_bf16 v[40:43], v[64:67], a[104:107], v[40:43]
    v_mul_f32_e64 v23, v23, |v23|
    buffer_load_dwordx4 v206, s[12:15], s46 offen offset:0 lds
    v_mfma_f32_16x16x32_bf16 v[44:47], v[64:67], a[108:111], v[44:47]
    v_cvt_pk_bf16_f32 v111, v22, v23
    s_waitcnt lgkmcnt(8)
    v_mfma_f32_16x16x32_bf16 v[32:35], v[68:71], a[112:115], v[32:35]
    ds_read_b64_tr_b16 v[56:57], v196 offset:49152
    v_pk_max_i16 v111, v111, 0
    v_mfma_f32_16x16x32_bf16 v[36:39], v[68:71], a[116:119], v[36:39]
    ds_read_b64_tr_b16 v[58:59], v197 offset:49152
    buffer_load_dwordx4 v207, s[12:15], s46 offen offset:1024 lds
    v_mfma_f32_16x16x32_bf16 v[40:43], v[68:71], a[120:123], v[40:43]
    v_mul_f32_e64 v24, v24, |v24|
    ds_read_b128 v[80:83], v220 offset:1024
    v_mfma_f32_16x16x32_bf16 v[44:47], v[68:71], a[124:127], v[44:47]
    v_mul_f32_e64 v25, v25, |v25|
    s_waitcnt lgkmcnt(9)
    v_mfma_f32_16x16x32_bf16 v[32:35], v[72:75], a[128:131], v[32:35]
    ds_read_b64_tr_b16 v[60:61], v196 offset:53248
    s_add_u32 m0, s31, 131072
    v_mfma_f32_16x16x32_bf16 v[36:39], v[72:75], a[132:135], v[36:39]
    ds_read_b64_tr_b16 v[62:63], v197 offset:53248
    buffer_load_dwordx4 v206, s[12:15], s47 offen offset:0 lds
    v_mfma_f32_16x16x32_bf16 v[40:43], v[72:75], a[136:139], v[40:43]
    v_cvt_pk_bf16_f32 v112, v24, v25
    v_pk_max_i16 v112, v112, 0
    v_mfma_f32_16x16x32_bf16 v[44:47], v[72:75], a[140:143], v[44:47]
    s_waitcnt lgkmcnt(9)
    v_mfma_f32_16x16x32_bf16 v[32:35], v[76:79], a[144:147], v[32:35]
    ds_read_b64_tr_b16 v[64:65], v196 offset:57344
    v_mul_f32_e64 v26, v26, |v26|
    v_mfma_f32_16x16x32_bf16 v[36:39], v[76:79], a[148:151], v[36:39]
    ds_read_b64_tr_b16 v[66:67], v197 offset:57344
    buffer_load_dwordx4 v207, s[12:15], s47 offen offset:1024 lds
    v_mfma_f32_16x16x32_bf16 v[40:43], v[76:79], a[152:155], v[40:43]
    v_mul_f32_e64 v27, v27, |v27|
    v_mfma_f32_16x16x32_bf16 v[44:47], v[76:79], a[156:159], v[44:47]
    v_cvt_pk_bf16_f32 v113, v26, v27
    s_waitcnt lgkmcnt(9)
    v_mfma_f32_16x16x32_bf16 v[32:35], v[48:51], a[160:163], v[32:35]
    ds_read_b64_tr_b16 v[68:69], v196 offset:61440
    s_add_u32 m0, s31, 139264
    v_mfma_f32_16x16x32_bf16 v[36:39], v[48:51], a[164:167], v[36:39]
    ds_read_b64_tr_b16 v[70:71], v197 offset:61440
    buffer_load_dwordx4 v206, s[12:15], s48 offen offset:0 lds
    v_mfma_f32_16x16x32_bf16 v[40:43], v[48:51], a[168:171], v[40:43]
    v_pk_max_i16 v113, v113, 0
    v_mfma_f32_16x16x32_bf16 v[44:47], v[48:51], a[172:175], v[44:47]
    v_mul_f32_e64 v28, v28, |v28|
    s_waitcnt lgkmcnt(9)
    v_mfma_f32_16x16x32_bf16 v[32:35], v[52:55], a[176:179], v[32:35]
    ds_read_b64_tr_b16 v[72:73], v198 offset:0
    v_mul_f32_e64 v29, v29, |v29|
    v_mfma_f32_16x16x32_bf16 v[36:39], v[52:55], a[180:183], v[36:39]
    ds_read_b64_tr_b16 v[74:75], v199 offset:0
    buffer_load_dwordx4 v207, s[12:15], s48 offen offset:1024 lds
    v_mfma_f32_16x16x32_bf16 v[40:43], v[52:55], a[184:187], v[40:43]
    v_cvt_pk_bf16_f32 v114, v28, v29
    v_mfma_f32_16x16x32_bf16 v[44:47], v[52:55], a[188:191], v[44:47]
    v_pk_max_i16 v114, v114, 0
    s_waitcnt vmcnt(12)
    s_barrier
    s_waitcnt lgkmcnt(9)
    v_mfma_f32_16x16x32_bf16 v[32:35], v[56:59], a[192:195], v[32:35]
    ds_read_b64_tr_b16 v[76:77], v198 offset:4096
    v_add_u32 v206, s63, v208
    v_mfma_f32_16x16x32_bf16 v[36:39], v[56:59], a[196:199], v[36:39]
    ds_read_b64_tr_b16 v[78:79], v199 offset:4096
    v_add_u32 v207, s63, v209
    v_mfma_f32_16x16x32_bf16 v[40:43], v[56:59], a[200:203], v[40:43]
    s_add_u32 m0, s31, 0
    v_mul_f32_e64 v30, v30, |v30|
    v_mfma_f32_16x16x32_bf16 v[44:47], v[56:59], a[204:207], v[44:47]
    buffer_load_dwordx4 v206, s[12:15], s40 offen offset:0 lds
    s_waitcnt lgkmcnt(8)
    v_mfma_f32_16x16x32_bf16 v[32:35], v[60:63], a[208:211], v[32:35]
    ds_read_b64_tr_b16 v[48:49], v198 offset:8192
    v_mul_f32_e64 v31, v31, |v31|
    v_mfma_f32_16x16x32_bf16 v[36:39], v[60:63], a[212:215], v[36:39]
    ds_read_b64_tr_b16 v[50:51], v199 offset:8192
    v_cvt_pk_bf16_f32 v115, v30, v31
    v_mfma_f32_16x16x32_bf16 v[40:43], v[60:63], a[216:219], v[40:43]
    buffer_load_dwordx4 v207, s[12:15], s40 offen offset:1024 lds
    v_pk_max_i16 v115, v115, 0
    v_mfma_f32_16x16x32_bf16 v[44:47], v[60:63], a[220:223], v[44:47]
    s_waitcnt lgkmcnt(8)
    v_mfma_f32_16x16x32_bf16 v[32:35], v[64:67], a[224:227], v[32:35]
    ds_read_b64_tr_b16 v[52:53], v198 offset:12288
    s_add_u32 m0, s31, 8192
    v_mfma_f32_16x16x32_bf16 v[36:39], v[64:67], a[228:231], v[36:39]
    ds_read_b64_tr_b16 v[54:55], v199 offset:12288
    buffer_load_dwordx4 v206, s[12:15], s41 offen offset:0 lds
    v_mfma_f32_16x16x32_bf16 v[40:43], v[64:67], a[232:235], v[40:43]
    v_mfma_f32_16x16x32_bf16 v[44:47], v[64:67], a[236:239], v[44:47]
    s_waitcnt lgkmcnt(8)
    v_mfma_f32_16x16x32_bf16 v[32:35], v[68:71], a[240:243], v[32:35]
    ds_read_b64_tr_b16 v[56:57], v198 offset:16384
    v_mfma_f32_16x16x32_bf16 v[36:39], v[68:71], a[244:247], v[36:39]
    ds_read_b64_tr_b16 v[58:59], v199 offset:16384
    buffer_load_dwordx4 v207, s[12:15], s41 offen offset:1024 lds
    v_mfma_f32_16x16x32_bf16 v[40:43], v[68:71], a[248:251], v[40:43]
    v_mfma_f32_16x16x32_bf16 v[44:47], v[68:71], a[252:255], v[44:47]
    s_waitcnt lgkmcnt(8)
    v_mfma_f32_16x16x32_bf16 v[32:35], v[72:75], v[164:167], v[32:35]
    ds_read_b64_tr_b16 v[60:61], v198 offset:20480
    s_add_u32 m0, s31, 16384
    v_mfma_f32_16x16x32_bf16 v[36:39], v[72:75], v[168:171], v[36:39]
    ds_read_b64_tr_b16 v[62:63], v199 offset:20480
    buffer_load_dwordx4 v206, s[12:15], s42 offen offset:0 lds
    v_mfma_f32_16x16x32_bf16 v[40:43], v[72:75], v[172:175], v[40:43]
    v_mfma_f32_16x16x32_bf16 v[44:47], v[72:75], v[176:179], v[44:47]
    s_waitcnt lgkmcnt(8)
    v_mfma_f32_16x16x32_bf16 v[32:35], v[76:79], v[180:183], v[32:35]
    ds_read_b64_tr_b16 v[64:65], v198 offset:24576
    v_mfma_f32_16x16x32_bf16 v[36:39], v[76:79], v[184:187], v[36:39]
    ds_read_b64_tr_b16 v[66:67], v199 offset:24576
    buffer_load_dwordx4 v207, s[12:15], s42 offen offset:1024 lds
    v_mfma_f32_16x16x32_bf16 v[40:43], v[76:79], v[188:191], v[40:43]
    v_mfma_f32_16x16x32_bf16 v[44:47], v[76:79], v[192:195], v[44:47]
    s_waitcnt vmcnt(12)
    s_barrier
    s_waitcnt lgkmcnt(8)
    v_mfma_f32_16x16x32_bf16 v[16:19], v[48:51], a[0:3], v[80:83]
    ds_read_b64_tr_b16 v[68:69], v198 offset:28672
    v_mfma_f32_16x16x32_bf16 v[20:23], v[48:51], a[4:7], v[80:83]
    ds_read_b64_tr_b16 v[70:71], v199 offset:28672
    s_add_u32 m0, s31, 24576
    v_mfma_f32_16x16x32_bf16 v[24:27], v[48:51], a[8:11], v[80:83]
    buffer_load_dwordx4 v206, s[12:15], s43 offen offset:0 lds
    v_mfma_f32_16x16x32_bf16 v[28:31], v[48:51], a[12:15], v[80:83]
    s_waitcnt lgkmcnt(8)
    v_mfma_f32_16x16x32_bf16 v[16:19], v[52:55], a[16:19], v[16:19]
    ds_read_b64_tr_b16 v[72:73], v198 offset:32768
    v_mul_f32_e64 v32, v32, |v32|
    v_mfma_f32_16x16x32_bf16 v[20:23], v[52:55], a[20:23], v[20:23]
    ds_read_b64_tr_b16 v[74:75], v199 offset:32768
    buffer_load_dwordx4 v207, s[12:15], s43 offen offset:1024 lds
    v_mfma_f32_16x16x32_bf16 v[24:27], v[52:55], a[24:27], v[24:27]
    v_mul_f32_e64 v33, v33, |v33|
    v_mfma_f32_16x16x32_bf16 v[28:31], v[52:55], a[28:31], v[28:31]
    v_cvt_pk_bf16_f32 v116, v32, v33
    s_waitcnt lgkmcnt(8)
    v_mfma_f32_16x16x32_bf16 v[16:19], v[56:59], a[32:35], v[16:19]
    ds_read_b64_tr_b16 v[76:77], v198 offset:36864
    s_add_u32 m0, s31, 32768
    v_mfma_f32_16x16x32_bf16 v[20:23], v[56:59], a[36:39], v[20:23]
    ds_read_b64_tr_b16 v[78:79], v199 offset:36864
    v_pk_max_i16 v116, v116, 0
    v_mfma_f32_16x16x32_bf16 v[24:27], v[56:59], a[40:43], v[24:27]
    buffer_load_dwordx4 v206, s[12:15], s44 offen offset:0 lds
    v_mul_f32_e64 v34, v34, |v34|
    v_mfma_f32_16x16x32_bf16 v[28:31], v[56:59], a[44:47], v[28:31]
    s_waitcnt lgkmcnt(8)
    v_mfma_f32_16x16x32_bf16 v[16:19], v[60:63], a[48:51], v[16:19]
    ds_read_b64_tr_b16 v[48:49], v198 offset:40960
    v_mul_f32_e64 v35, v35, |v35|
    v_mfma_f32_16x16x32_bf16 v[20:23], v[60:63], a[52:55], v[20:23]
    ds_read_b64_tr_b16 v[50:51], v199 offset:40960
    buffer_load_dwordx4 v207, s[12:15], s44 offen offset:1024 lds
    v_mfma_f32_16x16x32_bf16 v[24:27], v[60:63], a[56:59], v[24:27]
    v_cvt_pk_bf16_f32 v117, v34, v35
    v_mfma_f32_16x16x32_bf16 v[28:31], v[60:63], a[60:63], v[28:31]
    v_pk_max_i16 v117, v117, 0
    s_waitcnt lgkmcnt(8)
    v_mfma_f32_16x16x32_bf16 v[16:19], v[64:67], a[64:67], v[16:19]
    ds_read_b64_tr_b16 v[52:53], v198 offset:45056
    s_add_u32 m0, s31, 40960
    v_mfma_f32_16x16x32_bf16 v[20:23], v[64:67], a[68:71], v[20:23]
    ds_read_b64_tr_b16 v[54:55], v199 offset:45056
    buffer_load_dwordx4 v206, s[12:15], s45 offen offset:0 lds
    v_mfma_f32_16x16x32_bf16 v[24:27], v[64:67], a[72:75], v[24:27]
    v_mul_f32_e64 v36, v36, |v36|
    v_mul_f32_e64 v37, v37, |v37|
    v_mfma_f32_16x16x32_bf16 v[28:31], v[64:67], a[76:79], v[28:31]
    s_waitcnt lgkmcnt(8)
    v_mfma_f32_16x16x32_bf16 v[16:19], v[68:71], a[80:83], v[16:19]
    ds_read_b64_tr_b16 v[56:57], v198 offset:49152
    v_cvt_pk_bf16_f32 v120, v36, v37
    v_mfma_f32_16x16x32_bf16 v[20:23], v[68:71], a[84:87], v[20:23]
    ds_read_b64_tr_b16 v[58:59], v199 offset:49152
    buffer_load_dwordx4 v207, s[12:15], s45 offen offset:1024 lds
    v_mfma_f32_16x16x32_bf16 v[24:27], v[68:71], a[88:91], v[24:27]
    v_pk_max_i16 v120, v120, 0
    v_mfma_f32_16x16x32_bf16 v[28:31], v[68:71], a[92:95], v[28:31]
    v_mul_f32_e64 v38, v38, |v38|
    s_waitcnt vmcnt(12)
    s_barrier
    s_waitcnt lgkmcnt(8)
    v_mfma_f32_16x16x32_bf16 v[16:19], v[72:75], a[96:99], v[16:19]
    ds_read_b64_tr_b16 v[60:61], v198 offset:53248
    v_mfma_f32_16x16x32_bf16 v[20:23], v[72:75], a[100:103], v[20:23]
    ds_read_b64_tr_b16 v[62:63], v199 offset:53248
    s_add_u32 m0, s31, 49152
    v_mfma_f32_16x16x32_bf16 v[24:27], v[72:75], a[104:107], v[24:27]
    v_mul_f32_e64 v39, v39, |v39|
    buffer_load_dwordx4 v206, s[12:15], s46 offen offset:0 lds
    v_mfma_f32_16x16x32_bf16 v[28:31], v[72:75], a[108:111], v[28:31]
    v_cvt_pk_bf16_f32 v121, v38, v39
    s_waitcnt lgkmcnt(8)
    v_mfma_f32_16x16x32_bf16 v[16:19], v[76:79], a[112:115], v[16:19]
    ds_read_b64_tr_b16 v[64:65], v198 offset:57344
    v_pk_max_i16 v121, v121, 0
    v_mfma_f32_16x16x32_bf16 v[20:23], v[76:79], a[116:119], v[20:23]
    ds_read_b64_tr_b16 v[66:67], v199 offset:57344
    buffer_load_dwordx4 v207, s[12:15], s46 offen offset:1024 lds
    v_mfma_f32_16x16x32_bf16 v[24:27], v[76:79], a[120:123], v[24:27]
    v_mul_f32_e64 v40, v40, |v40|
    ds_read_b128 v[80:83], v220 offset:1280
    v_mfma_f32_16x16x32_bf16 v[28:31], v[76:79], a[124:127], v[28:31]
    v_mul_f32_e64 v41, v41, |v41|
    s_waitcnt lgkmcnt(9)
    v_mfma_f32_16x16x32_bf16 v[16:19], v[48:51], a[128:131], v[16:19]
    ds_read_b64_tr_b16 v[68:69], v198 offset:61440
    s_add_u32 m0, s31, 57344
    v_mfma_f32_16x16x32_bf16 v[20:23], v[48:51], a[132:135], v[20:23]
    ds_read_b64_tr_b16 v[70:71], v199 offset:61440
    buffer_load_dwordx4 v206, s[12:15], s47 offen offset:0 lds
    v_mfma_f32_16x16x32_bf16 v[24:27], v[48:51], a[136:139], v[24:27]
    v_cvt_pk_bf16_f32 v124, v40, v41
    v_pk_max_i16 v124, v124, 0
    v_mfma_f32_16x16x32_bf16 v[28:31], v[48:51], a[140:143], v[28:31]
    s_waitcnt lgkmcnt(9)
    v_mfma_f32_16x16x32_bf16 v[16:19], v[52:55], a[144:147], v[16:19]
    ds_read_b64_tr_b16 v[72:73], v200 offset:0
    v_mul_f32_e64 v42, v42, |v42|
    v_mfma_f32_16x16x32_bf16 v[20:23], v[52:55], a[148:151], v[20:23]
    ds_read_b64_tr_b16 v[74:75], v201 offset:0
    buffer_load_dwordx4 v207, s[12:15], s47 offen offset:1024 lds
    v_mfma_f32_16x16x32_bf16 v[24:27], v[52:55], a[152:155], v[24:27]
    v_mul_f32_e64 v43, v43, |v43|
    v_mfma_f32_16x16x32_bf16 v[28:31], v[52:55], a[156:159], v[28:31]
    v_cvt_pk_bf16_f32 v125, v42, v43
    s_waitcnt lgkmcnt(9)
    v_mfma_f32_16x16x32_bf16 v[16:19], v[56:59], a[160:163], v[16:19]
    ds_read_b64_tr_b16 v[76:77], v200 offset:4096
    s_add_u32 m0, s31, 65536
    v_mfma_f32_16x16x32_bf16 v[20:23], v[56:59], a[164:167], v[20:23]
    ds_read_b64_tr_b16 v[78:79], v201 offset:4096
    buffer_load_dwordx4 v206, s[12:15], s48 offen offset:0 lds
    v_mfma_f32_16x16x32_bf16 v[24:27], v[56:59], a[168:171], v[24:27]
    v_pk_max_i16 v125, v125, 0
    v_mfma_f32_16x16x32_bf16 v[28:31], v[56:59], a[172:175], v[28:31]
    v_mul_f32_e64 v44, v44, |v44|
    s_waitcnt lgkmcnt(9)
    v_mfma_f32_16x16x32_bf16 v[16:19], v[60:63], a[176:179], v[16:19]
    ds_read_b64_tr_b16 v[48:49], v200 offset:8192
    v_mul_f32_e64 v45, v45, |v45|
    v_mfma_f32_16x16x32_bf16 v[20:23], v[60:63], a[180:183], v[20:23]
    ds_read_b64_tr_b16 v[50:51], v201 offset:8192
    buffer_load_dwordx4 v207, s[12:15], s48 offen offset:1024 lds
    v_mfma_f32_16x16x32_bf16 v[24:27], v[60:63], a[184:187], v[24:27]
    v_cvt_pk_bf16_f32 v128, v44, v45
    v_mfma_f32_16x16x32_bf16 v[28:31], v[60:63], a[188:191], v[28:31]
    v_pk_max_i16 v128, v128, 0
    s_waitcnt vmcnt(12)
    s_barrier
    s_waitcnt lgkmcnt(9)
    v_mfma_f32_16x16x32_bf16 v[16:19], v[64:67], a[192:195], v[16:19]
    ds_read_b64_tr_b16 v[52:53], v200 offset:12288
    v_add_u32 v206, s64, v208
    v_mfma_f32_16x16x32_bf16 v[20:23], v[64:67], a[196:199], v[20:23]
    ds_read_b64_tr_b16 v[54:55], v201 offset:12288
    v_add_u32 v207, s64, v209
    v_mfma_f32_16x16x32_bf16 v[24:27], v[64:67], a[200:203], v[24:27]
    s_add_u32 m0, s31, 73728
    v_mul_f32_e64 v46, v46, |v46|
    v_mfma_f32_16x16x32_bf16 v[28:31], v[64:67], a[204:207], v[28:31]
    buffer_load_dwordx4 v206, s[12:15], s40 offen offset:0 lds
    s_waitcnt lgkmcnt(8)
    v_mfma_f32_16x16x32_bf16 v[16:19], v[68:71], a[208:211], v[16:19]
    ds_read_b64_tr_b16 v[56:57], v196 offset:0
    v_mul_f32_e64 v47, v47, |v47|
    v_mfma_f32_16x16x32_bf16 v[20:23], v[68:71], a[212:215], v[20:23]
    ds_read_b64_tr_b16 v[58:59], v197 offset:0
    v_cvt_pk_bf16_f32 v129, v46, v47
    v_mfma_f32_16x16x32_bf16 v[24:27], v[68:71], a[216:219], v[24:27]
    buffer_load_dwordx4 v207, s[12:15], s40 offen offset:1024 lds
    v_pk_max_i16 v129, v129, 0
    v_mfma_f32_16x16x32_bf16 v[28:31], v[68:71], a[220:223], v[28:31]
    s_waitcnt lgkmcnt(8)
    v_mfma_f32_16x16x32_bf16 v[16:19], v[72:75], a[224:227], v[16:19]
    ds_read_b64_tr_b16 v[60:61], v196 offset:4096
    s_add_u32 m0, s31, 81920
    v_mfma_f32_16x16x32_bf16 v[20:23], v[72:75], a[228:231], v[20:23]
    ds_read_b64_tr_b16 v[62:63], v197 offset:4096
    buffer_load_dwordx4 v206, s[12:15], s41 offen offset:0 lds
    v_mfma_f32_16x16x32_bf16 v[24:27], v[72:75], a[232:235], v[24:27]
    v_mfma_f32_16x16x32_bf16 v[28:31], v[72:75], a[236:239], v[28:31]
    s_waitcnt lgkmcnt(8)
    v_mfma_f32_16x16x32_bf16 v[16:19], v[76:79], a[240:243], v[16:19]
    ds_read_b64_tr_b16 v[64:65], v196 offset:8192
    v_mfma_f32_16x16x32_bf16 v[20:23], v[76:79], a[244:247], v[20:23]
    ds_read_b64_tr_b16 v[66:67], v197 offset:8192
    buffer_load_dwordx4 v207, s[12:15], s41 offen offset:1024 lds
    v_mfma_f32_16x16x32_bf16 v[24:27], v[76:79], a[248:251], v[24:27]
    v_mfma_f32_16x16x32_bf16 v[28:31], v[76:79], a[252:255], v[28:31]
    s_waitcnt lgkmcnt(8)
    v_mfma_f32_16x16x32_bf16 v[16:19], v[48:51], v[164:167], v[16:19]
    ds_read_b64_tr_b16 v[68:69], v196 offset:12288
    s_add_u32 m0, s31, 90112
    v_mfma_f32_16x16x32_bf16 v[20:23], v[48:51], v[168:171], v[20:23]
    ds_read_b64_tr_b16 v[70:71], v197 offset:12288
    buffer_load_dwordx4 v206, s[12:15], s42 offen offset:0 lds
    v_mfma_f32_16x16x32_bf16 v[24:27], v[48:51], v[172:175], v[24:27]
    v_mfma_f32_16x16x32_bf16 v[28:31], v[48:51], v[176:179], v[28:31]
    s_waitcnt lgkmcnt(8)
    v_mfma_f32_16x16x32_bf16 v[16:19], v[52:55], v[180:183], v[16:19]
    ds_read_b64_tr_b16 v[72:73], v196 offset:16384
    v_mfma_f32_16x16x32_bf16 v[20:23], v[52:55], v[184:187], v[20:23]
    ds_read_b64_tr_b16 v[74:75], v197 offset:16384
    buffer_load_dwordx4 v207, s[12:15], s42 offen offset:1024 lds
    v_mfma_f32_16x16x32_bf16 v[24:27], v[52:55], v[188:191], v[24:27]
    v_mfma_f32_16x16x32_bf16 v[28:31], v[52:55], v[192:195], v[28:31]
    s_waitcnt vmcnt(12)
    s_barrier
    s_waitcnt lgkmcnt(8)
    v_mfma_f32_16x16x32_bf16 v[32:35], v[56:59], a[0:3], v[80:83]
    ds_read_b64_tr_b16 v[76:77], v196 offset:20480
    v_mfma_f32_16x16x32_bf16 v[36:39], v[56:59], a[4:7], v[80:83]
    ds_read_b64_tr_b16 v[78:79], v197 offset:20480
    s_add_u32 m0, s31, 98304
    v_mfma_f32_16x16x32_bf16 v[40:43], v[56:59], a[8:11], v[80:83]
    buffer_load_dwordx4 v206, s[12:15], s43 offen offset:0 lds
    v_mfma_f32_16x16x32_bf16 v[44:47], v[56:59], a[12:15], v[80:83]
    s_waitcnt lgkmcnt(8)
    v_mfma_f32_16x16x32_bf16 v[32:35], v[60:63], a[16:19], v[32:35]
    ds_read_b64_tr_b16 v[48:49], v196 offset:24576
    v_mul_f32_e64 v16, v16, |v16|
    v_mfma_f32_16x16x32_bf16 v[36:39], v[60:63], a[20:23], v[36:39]
    ds_read_b64_tr_b16 v[50:51], v197 offset:24576
    buffer_load_dwordx4 v207, s[12:15], s43 offen offset:1024 lds
    v_mfma_f32_16x16x32_bf16 v[40:43], v[60:63], a[24:27], v[40:43]
    v_mul_f32_e64 v17, v17, |v17|
    v_mfma_f32_16x16x32_bf16 v[44:47], v[60:63], a[28:31], v[44:47]
    v_cvt_pk_bf16_f32 v118, v16, v17
    s_waitcnt lgkmcnt(8)
    v_mfma_f32_16x16x32_bf16 v[32:35], v[64:67], a[32:35], v[32:35]
    ds_read_b64_tr_b16 v[52:53], v196 offset:28672
    s_add_u32 m0, s31, 106496
    v_mfma_f32_16x16x32_bf16 v[36:39], v[64:67], a[36:39], v[36:39]
    ds_read_b64_tr_b16 v[54:55], v197 offset:28672
    v_pk_max_i16 v118, v118, 0
    v_mfma_f32_16x16x32_bf16 v[40:43], v[64:67], a[40:43], v[40:43]
    buffer_load_dwordx4 v206, s[12:15], s44 offen offset:0 lds
    v_mul_f32_e64 v18, v18, |v18|
    v_mfma_f32_16x16x32_bf16 v[44:47], v[64:67], a[44:47], v[44:47]
    s_waitcnt lgkmcnt(8)
    v_mfma_f32_16x16x32_bf16 v[32:35], v[68:71], a[48:51], v[32:35]
    ds_read_b64_tr_b16 v[56:57], v196 offset:32768
    v_mul_f32_e64 v19, v19, |v19|
    v_mfma_f32_16x16x32_bf16 v[36:39], v[68:71], a[52:55], v[36:39]
    ds_read_b64_tr_b16 v[58:59], v197 offset:32768
    buffer_load_dwordx4 v207, s[12:15], s44 offen offset:1024 lds
    v_mfma_f32_16x16x32_bf16 v[40:43], v[68:71], a[56:59], v[40:43]
    v_cvt_pk_bf16_f32 v119, v18, v19
    v_mfma_f32_16x16x32_bf16 v[44:47], v[68:71], a[60:63], v[44:47]
    v_pk_max_i16 v119, v119, 0
    s_waitcnt lgkmcnt(8)
    v_mfma_f32_16x16x32_bf16 v[32:35], v[72:75], a[64:67], v[32:35]
    ds_read_b64_tr_b16 v[60:61], v196 offset:36864
    s_add_u32 m0, s31, 114688
    v_mfma_f32_16x16x32_bf16 v[36:39], v[72:75], a[68:71], v[36:39]
    ds_read_b64_tr_b16 v[62:63], v197 offset:36864
    buffer_load_dwordx4 v206, s[12:15], s45 offen offset:0 lds
    v_mfma_f32_16x16x32_bf16 v[40:43], v[72:75], a[72:75], v[40:43]
    v_mul_f32_e64 v20, v20, |v20|
    v_mul_f32_e64 v21, v21, |v21|
    v_mfma_f32_16x16x32_bf16 v[44:47], v[72:75], a[76:79], v[44:47]
    s_waitcnt lgkmcnt(8)
    v_mfma_f32_16x16x32_bf16 v[32:35], v[76:79], a[80:83], v[32:35]
    ds_read_b64_tr_b16 v[64:65], v196 offset:40960
    v_cvt_pk_bf16_f32 v122, v20, v21
    v_mfma_f32_16x16x32_bf16 v[36:39], v[76:79], a[84:87], v[36:39]
    ds_read_b64_tr_b16 v[66:67], v197 offset:40960
    buffer_load_dwordx4 v207, s[12:15], s45 offen offset:1024 lds
    v_mfma_f32_16x16x32_bf16 v[40:43], v[76:79], a[88:91], v[40:43]
    v_pk_max_i16 v122, v122, 0
    v_mfma_f32_16x16x32_bf16 v[44:47], v[76:79], a[92:95], v[44:47]
    v_mul_f32_e64 v22, v22, |v22|
    s_waitcnt vmcnt(12)
    s_barrier
    s_waitcnt lgkmcnt(8)
    v_mfma_f32_16x16x32_bf16 v[32:35], v[48:51], a[96:99], v[32:35]
    ds_read_b64_tr_b16 v[68:69], v196 offset:45056
    v_mfma_f32_16x16x32_bf16 v[36:39], v[48:51], a[100:103], v[36:39]
    ds_read_b64_tr_b16 v[70:71], v197 offset:45056
    s_add_u32 m0, s31, 122880
    v_mfma_f32_16x16x32_bf16 v[40:43], v[48:51], a[104:107], v[40:43]
    v_mul_f32_e64 v23, v23, |v23|
    buffer_load_dwordx4 v206, s[12:15], s46 offen offset:0 lds
    v_mfma_f32_16x16x32_bf16 v[44:47], v[48:51], a[108:111], v[44:47]
    v_cvt_pk_bf16_f32 v123, v22, v23
    s_waitcnt lgkmcnt(8)
    v_mfma_f32_16x16x32_bf16 v[32:35], v[52:55], a[112:115], v[32:35]
    ds_read_b64_tr_b16 v[72:73], v196 offset:49152
    v_pk_max_i16 v123, v123, 0
    v_mfma_f32_16x16x32_bf16 v[36:39], v[52:55], a[116:119], v[36:39]
    ds_read_b64_tr_b16 v[74:75], v197 offset:49152
    buffer_load_dwordx4 v207, s[12:15], s46 offen offset:1024 lds
    v_mfma_f32_16x16x32_bf16 v[40:43], v[52:55], a[120:123], v[40:43]
    v_mul_f32_e64 v24, v24, |v24|
    ds_read_b128 v[80:83], v220 offset:1536
    v_mfma_f32_16x16x32_bf16 v[44:47], v[52:55], a[124:127], v[44:47]
    v_mul_f32_e64 v25, v25, |v25|
    s_waitcnt lgkmcnt(9)
    v_mfma_f32_16x16x32_bf16 v[32:35], v[56:59], a[128:131], v[32:35]
    ds_read_b64_tr_b16 v[76:77], v196 offset:53248
    s_add_u32 m0, s31, 131072
    v_mfma_f32_16x16x32_bf16 v[36:39], v[56:59], a[132:135], v[36:39]
    ds_read_b64_tr_b16 v[78:79], v197 offset:53248
    buffer_load_dwordx4 v206, s[12:15], s47 offen offset:0 lds
    v_mfma_f32_16x16x32_bf16 v[40:43], v[56:59], a[136:139], v[40:43]
    v_cvt_pk_bf16_f32 v126, v24, v25
    v_pk_max_i16 v126, v126, 0
    v_mfma_f32_16x16x32_bf16 v[44:47], v[56:59], a[140:143], v[44:47]
    s_waitcnt lgkmcnt(9)
    v_mfma_f32_16x16x32_bf16 v[32:35], v[60:63], a[144:147], v[32:35]
    ds_read_b64_tr_b16 v[48:49], v196 offset:57344
    v_mul_f32_e64 v26, v26, |v26|
    v_mfma_f32_16x16x32_bf16 v[36:39], v[60:63], a[148:151], v[36:39]
    ds_read_b64_tr_b16 v[50:51], v197 offset:57344
    buffer_load_dwordx4 v207, s[12:15], s47 offen offset:1024 lds
    v_mfma_f32_16x16x32_bf16 v[40:43], v[60:63], a[152:155], v[40:43]
    v_mul_f32_e64 v27, v27, |v27|
    v_mfma_f32_16x16x32_bf16 v[44:47], v[60:63], a[156:159], v[44:47]
    v_cvt_pk_bf16_f32 v127, v26, v27
    s_waitcnt lgkmcnt(9)
    v_mfma_f32_16x16x32_bf16 v[32:35], v[64:67], a[160:163], v[32:35]
    ds_read_b64_tr_b16 v[52:53], v196 offset:61440
    s_add_u32 m0, s31, 139264
    v_mfma_f32_16x16x32_bf16 v[36:39], v[64:67], a[164:167], v[36:39]
    ds_read_b64_tr_b16 v[54:55], v197 offset:61440
    buffer_load_dwordx4 v206, s[12:15], s48 offen offset:0 lds
    v_mfma_f32_16x16x32_bf16 v[40:43], v[64:67], a[168:171], v[40:43]
    v_pk_max_i16 v127, v127, 0
    v_mfma_f32_16x16x32_bf16 v[44:47], v[64:67], a[172:175], v[44:47]
    v_mul_f32_e64 v28, v28, |v28|
L_pg6:
    s_cbranch_vccnz L_pg10
    s_waitcnt lgkmcnt(9)
    v_mfma_f32_16x16x32_bf16 v[32:35], v[68:71], a[176:179], v[32:35]
    ds_read_b64_tr_b16 v[56:57], v198 offset:0
    v_mul_f32_e64 v29, v29, |v29|
    v_mfma_f32_16x16x32_bf16 v[36:39], v[68:71], a[180:183], v[36:39]
    ds_read_b64_tr_b16 v[58:59], v199 offset:0
    buffer_load_dwordx4 v207, s[12:15], s48 offen offset:1024 lds
    v_mfma_f32_16x16x32_bf16 v[40:43], v[68:71], a[184:187], v[40:43]
L_pg7:
    s_cbranch_vccnz L_pg11
    v_cvt_pk_bf16_f32 v130, v28, v29
    v_mfma_f32_16x16x32_bf16 v[44:47], v[68:71], a[188:191], v[44:47]
    v_pk_max_i16 v130, v130, 0
    s_waitcnt vmcnt(12)
    s_barrier
    s_waitcnt lgkmcnt(9)
    v_mfma_f32_16x16x32_bf16 v[32:35], v[72:75], a[192:195], v[32:35]
    ds_read_b64_tr_b16 v[60:61], v198 offset:4096
    v_add_u32 v206, s65, v208
    v_mfma_f32_16x16x32_bf16 v[36:39], v[72:75], a[196:199], v[36:39]
L_pg8:
    s_cbranch_vccnz L_pg12
    ds_read_b64_tr_b16 v[62:63], v199 offset:4096
    v_add_u32 v207, s65, v209
    v_mfma_f32_16x16x32_bf16 v[40:43], v[72:75], a[200:203], v[40:43]
    s_add_u32 m0, s31, 0
    v_mul_f32_e64 v30, v30, |v30|
    v_mfma_f32_16x16x32_bf16 v[44:47], v[72:75], a[204:207], v[44:47]
    buffer_load_dwordx4 v206, s[12:15], s40 offen offset:0 lds
    s_waitcnt lgkmcnt(8)
    v_mfma_f32_16x16x32_bf16 v[32:35], v[76:79], a[208:211], v[32:35]
    ds_read_b64_tr_b16 v[64:65], v198 offset:8192
    v_mul_f32_e64 v31, v31, |v31|
    v_mfma_f32_16x16x32_bf16 v[36:39], v[76:79], a[212:215], v[36:39]
    ds_read_b64_tr_b16 v[66:67], v199 offset:8192
    v_cvt_pk_bf16_f32 v131, v30, v31
    v_mfma_f32_16x16x32_bf16 v[40:43], v[76:79], a[216:219], v[40:43]
    buffer_load_dwordx4 v207, s[12:15], s40 offen offset:1024 lds
    v_pk_max_i16 v131, v131, 0
    v_mfma_f32_16x16x32_bf16 v[44:47], v[76:79], a[220:223], v[44:47]
    s_waitcnt lgkmcnt(8)
    v_mfma_f32_16x16x32_bf16 v[32:35], v[48:51], a[224:227], v[32:35]
    ds_read_b64_tr_b16 v[68:69], v198 offset:12288
    s_add_u32 m0, s31, 8192
    v_mfma_f32_16x16x32_bf16 v[36:39], v[48:51], a[228:231], v[36:39]
    ds_read_b64_tr_b16 v[70:71], v199 offset:12288
    buffer_load_dwordx4 v206, s[12:15], s41 offen offset:0 lds
    v_mfma_f32_16x16x32_bf16 v[40:43], v[48:51], a[232:235], v[40:43]
    v_mfma_f32_16x16x32_bf16 v[44:47], v[48:51], a[236:239], v[44:47]
    s_waitcnt lgkmcnt(8)
    v_mfma_f32_16x16x32_bf16 v[32:35], v[52:55], a[240:243], v[32:35]
    ds_read_b64_tr_b16 v[72:73], v198 offset:16384
    v_mfma_f32_16x16x32_bf16 v[36:39], v[52:55], a[244:247], v[36:39]
    ds_read_b64_tr_b16 v[74:75], v199 offset:16384
    buffer_load_dwordx4 v207, s[12:15], s41 offen offset:1024 lds
    v_mfma_f32_16x16x32_bf16 v[40:43], v[52:55], a[248:251], v[40:43]
    v_mfma_f32_16x16x32_bf16 v[44:47], v[52:55], a[252:255], v[44:47]
    s_waitcnt lgkmcnt(8)
    v_mfma_f32_16x16x32_bf16 v[32:35], v[56:59], v[164:167], v[32:35]
    ds_read_b64_tr_b16 v[76:77], v198 offset:20480
    s_add_u32 m0, s31, 16384
    v_mfma_f32_16x16x32_bf16 v[36:39], v[56:59], v[168:171], v[36:39]
    ds_read_b64_tr_b16 v[78:79], v199 offset:20480
    buffer_load_dwordx4 v206, s[12:15], s42 offen offset:0 lds
    v_mfma_f32_16x16x32_bf16 v[40:43], v[56:59], v[172:175], v[40:43]
    v_mfma_f32_16x16x32_bf16 v[44:47], v[56:59], v[176:179], v[44:47]
    s_waitcnt lgkmcnt(8)
    v_mfma_f32_16x16x32_bf16 v[32:35], v[60:63], v[180:183], v[32:35]
    ds_read_b64_tr_b16 v[48:49], v198 offset:24576
    v_mfma_f32_16x16x32_bf16 v[36:39], v[60:63], v[184:187], v[36:39]
    ds_read_b64_tr_b16 v[50:51], v199 offset:24576
    buffer_load_dwordx4 v207, s[12:15], s42 offen offset:1024 lds
    v_mfma_f32_16x16x32_bf16 v[40:43], v[60:63], v[188:191], v[40:43]
    v_mfma_f32_16x16x32_bf16 v[44:47], v[60:63], v[192:195], v[44:47]
    s_waitcnt vmcnt(12)
    s_barrier
    s_waitcnt lgkmcnt(8)
    v_mfma_f32_16x16x32_bf16 v[16:19], v[64:67], a[0:3], v[80:83]
    ds_read_b64_tr_b16 v[52:53], v198 offset:28672
    v_mfma_f32_16x16x32_bf16 v[20:23], v[64:67], a[4:7], v[80:83]
    ds_read_b64_tr_b16 v[54:55], v199 offset:28672
    s_add_u32 m0, s31, 24576
    v_mfma_f32_16x16x32_bf16 v[24:27], v[64:67], a[8:11], v[80:83]
    buffer_load_dwordx4 v206, s[12:15], s43 offen offset:0 lds
    v_mfma_f32_16x16x32_bf16 v[28:31], v[64:67], a[12:15], v[80:83]
    s_waitcnt lgkmcnt(8)
    v_mfma_f32_16x16x32_bf16 v[16:19], v[68:71], a[16:19], v[16:19]
    ds_read_b64_tr_b16 v[56:57], v198 offset:32768
    v_mul_f32_e64 v32, v32, |v32|
    v_mfma_f32_16x16x32_bf16 v[20:23], v[68:71], a[20:23], v[20:23]
    ds_read_b64_tr_b16 v[58:59], v199 offset:32768
    buffer_load_dwordx4 v207, s[12:15], s43 offen offset:1024 lds
    v_mfma_f32_16x16x32_bf16 v[24:27], v[68:71], a[24:27], v[24:27]
    v_mul_f32_e64 v33, v33, |v33|
    v_mfma_f32_16x16x32_bf16 v[28:31], v[68:71], a[28:31], v[28:31]
    v_cvt_pk_bf16_f32 v132, v32, v33
    s_waitcnt lgkmcnt(8)
    v_mfma_f32_16x16x32_bf16 v[16:19], v[72:75], a[32:35], v[16:19]
    ds_read_b64_tr_b16 v[60:61], v198 offset:36864
    s_add_u32 m0, s31, 32768
    v_mfma_f32_16x16x32_bf16 v[20:23], v[72:75], a[36:39], v[20:23]
    ds_read_b64_tr_b16 v[62:63], v199 offset:36864
    v_pk_max_i16 v132, v132, 0
    v_mfma_f32_16x16x32_bf16 v[24:27], v[72:75], a[40:43], v[24:27]
    buffer_load_dwordx4 v206, s[12:15], s44 offen offset:0 lds
    v_mul_f32_e64 v34, v34, |v34|
    v_mfma_f32_16x16x32_bf16 v[28:31], v[72:75], a[44:47], v[28:31]
    s_waitcnt lgkmcnt(8)
    v_mfma_f32_16x16x32_bf16 v[16:19], v[76:79], a[48:51], v[16:19]
    ds_read_b64_tr_b16 v[64:65], v198 offset:40960
    v_mul_f32_e64 v35, v35, |v35|
    v_mfma_f32_16x16x32_bf16 v[20:23], v[76:79], a[52:55], v[20:23]
    ds_read_b64_tr_b16 v[66:67], v199 offset:40960
    buffer_load_dwordx4 v207, s[12:15], s44 offen offset:1024 lds
    v_mfma_f32_16x16x32_bf16 v[24:27], v[76:79], a[56:59], v[24:27]
    v_cvt_pk_bf16_f32 v133, v34, v35
    v_mfma_f32_16x16x32_bf16 v[28:31], v[76:79], a[60:63], v[28:31]
    v_pk_max_i16 v133, v133, 0
    s_waitcnt lgkmcnt(8)
    v_mfma_f32_16x16x32_bf16 v[16:19], v[48:51], a[64:67], v[16:19]
    ds_read_b64_tr_b16 v[68:69], v198 offset:45056
    s_add_u32 m0, s31, 40960
    v_mfma_f32_16x16x32_bf16 v[20:23], v[48:51], a[68:71], v[20:23]
    ds_read_b64_tr_b16 v[70:71], v199 offset:45056
    buffer_load_dwordx4 v206, s[12:15], s45 offen offset:0 lds
    v_mfma_f32_16x16x32_bf16 v[24:27], v[48:51], a[72:75], v[24:27]
    v_mul_f32_e64 v36, v36, |v36|
    v_mul_f32_e64 v37, v37, |v37|
    v_mfma_f32_16x16x32_bf16 v[28:31], v[48:51], a[76:79], v[28:31]
    s_waitcnt lgkmcnt(8)
    v_mfma_f32_16x16x32_bf16 v[16:19], v[52:55], a[80:83], v[16:19]
    ds_read_b64_tr_b16 v[72:73], v198 offset:49152
    v_cvt_pk_bf16_f32 v134, v36, v37
    v_mfma_f32_16x16x32_bf16 v[20:23], v[52:55], a[84:87], v[20:23]
    ds_read_b64_tr_b16 v[74:75], v199 offset:49152
    buffer_load_dwordx4 v207, s[12:15], s45 offen offset:1024 lds
    v_mfma_f32_16x16x32_bf16 v[24:27], v[52:55], a[88:91], v[24:27]
    v_pk_max_i16 v134, v134, 0
    v_mfma_f32_16x16x32_bf16 v[28:31], v[52:55], a[92:95], v[28:31]
    v_mul_f32_e64 v38, v38, |v38|
    s_waitcnt vmcnt(12)
    s_barrier
    s_waitcnt lgkmcnt(8)
    v_mfma_f32_16x16x32_bf16 v[16:19], v[56:59], a[96:99], v[16:19]
    ds_read_b64_tr_b16 v[76:77], v198 offset:53248
    v_mfma_f32_16x16x32_bf16 v[20:23], v[56:59], a[100:103], v[20:23]
    ds_read_b64_tr_b16 v[78:79], v199 offset:53248
    s_add_u32 m0, s31, 49152
    v_mfma_f32_16x16x32_bf16 v[24:27], v[56:59], a[104:107], v[24:27]
    v_mul_f32_e64 v39, v39, |v39|
    buffer_load_dwordx4 v206, s[12:15], s46 offen offset:0 lds
    v_mfma_f32_16x16x32_bf16 v[28:31], v[56:59], a[108:111], v[28:31]
    v_cvt_pk_bf16_f32 v135, v38, v39
    s_waitcnt lgkmcnt(8)
    v_mfma_f32_16x16x32_bf16 v[16:19], v[60:63], a[112:115], v[16:19]
    ds_read_b64_tr_b16 v[48:49], v198 offset:57344
    v_pk_max_i16 v135, v135, 0
    v_mfma_f32_16x16x32_bf16 v[20:23], v[60:63], a[116:119], v[20:23]
    ds_read_b64_tr_b16 v[50:51], v199 offset:57344
    buffer_load_dwordx4 v207, s[12:15], s46 offen offset:1024 lds
    v_mfma_f32_16x16x32_bf16 v[24:27], v[60:63], a[120:123], v[24:27]
    v_mul_f32_e64 v40, v40, |v40|
    ds_read_b128 v[80:83], v220 offset:1792
    v_mfma_f32_16x16x32_bf16 v[28:31], v[60:63], a[124:127], v[28:31]
    v_mul_f32_e64 v41, v41, |v41|
    s_waitcnt lgkmcnt(9)
    v_mfma_f32_16x16x32_bf16 v[16:19], v[64:67], a[128:131], v[16:19]
    ds_read_b64_tr_b16 v[52:53], v198 offset:61440
    s_add_u32 m0, s31, 57344
    v_mfma_f32_16x16x32_bf16 v[20:23], v[64:67], a[132:135], v[20:23]
    ds_read_b64_tr_b16 v[54:55], v199 offset:61440
    buffer_load_dwordx4 v206, s[12:15], s47 offen offset:0 lds
    v_mfma_f32_16x16x32_bf16 v[24:27], v[64:67], a[136:139], v[24:27]
    v_cvt_pk_bf16_f32 v136, v40, v41
    v_pk_max_i16 v136, v136, 0
    v_mfma_f32_16x16x32_bf16 v[28:31], v[64:67], a[140:143], v[28:31]
    s_waitcnt lgkmcnt(9)
    v_mfma_f32_16x16x32_bf16 v[16:19], v[68:71], a[144:147], v[16:19]
    ds_read_b64_tr_b16 v[56:57], v200 offset:0
    v_mul_f32_e64 v42, v42, |v42|
    v_mfma_f32_16x16x32_bf16 v[20:23], v[68:71], a[148:151], v[20:23]
    ds_read_b64_tr_b16 v[58:59], v201 offset:0
    buffer_load_dwordx4 v207, s[12:15], s47 offen offset:1024 lds
    v_mfma_f32_16x16x32_bf16 v[24:27], v[68:71], a[152:155], v[24:27]
    v_mul_f32_e64 v43, v43, |v43|
    v_mfma_f32_16x16x32_bf16 v[28:31], v[68:71], a[156:159], v[28:31]
    v_cvt_pk_bf16_f32 v137, v42, v43
    s_waitcnt lgkmcnt(9)
    v_mfma_f32_16x16x32_bf16 v[16:19], v[72:75], a[160:163], v[16:19]
    ds_read_b64_tr_b16 v[60:61], v200 offset:4096
    s_add_u32 m0, s31, 65536
    v_mfma_f32_16x16x32_bf16 v[20:23], v[72:75], a[164:167], v[20:23]
    ds_read_b64_tr_b16 v[62:63], v201 offset:4096
    buffer_load_dwordx4 v206, s[12:15], s48 offen offset:0 lds
    v_mfma_f32_16x16x32_bf16 v[24:27], v[72:75], a[168:171], v[24:27]
    v_pk_max_i16 v137, v137, 0
    v_mfma_f32_16x16x32_bf16 v[28:31], v[72:75], a[172:175], v[28:31]
    v_mul_f32_e64 v44, v44, |v44|
    s_waitcnt lgkmcnt(9)
    v_mfma_f32_16x16x32_bf16 v[16:19], v[76:79], a[176:179], v[16:19]
    ds_read_b64_tr_b16 v[64:65], v200 offset:8192
    v_mul_f32_e64 v45, v45, |v45|
    v_mfma_f32_16x16x32_bf16 v[20:23], v[76:79], a[180:183], v[20:23]
    ds_read_b64_tr_b16 v[66:67], v201 offset:8192
    buffer_load_dwordx4 v207, s[12:15], s48 offen offset:1024 lds
    v_mfma_f32_16x16x32_bf16 v[24:27], v[76:79], a[184:187], v[24:27]
    v_cvt_pk_bf16_f32 v138, v44, v45
    v_mfma_f32_16x16x32_bf16 v[28:31], v[76:79], a[188:191], v[28:31]
    v_pk_max_i16 v138, v138, 0
    s_waitcnt vmcnt(12)
    s_barrier
    s_waitcnt lgkmcnt(9)
    v_mfma_f32_16x16x32_bf16 v[16:19], v[48:51], a[192:195], v[16:19]
    ds_read_b64_tr_b16 v[68:69], v200 offset:12288
    v_add_u32 v206, s66, v208
    v_mfma_f32_16x16x32_bf16 v[20:23], v[48:51], a[196:199], v[20:23]
    ds_read_b64_tr_b16 v[70:71], v201 offset:12288
    v_add_u32 v207, s66, v209
    v_mfma_f32_16x16x32_bf16 v[24:27], v[48:51], a[200:203], v[24:27]
    s_add_u32 m0, s31, 73728
    v_mul_f32_e64 v46, v46, |v46|
    v_mfma_f32_16x16x32_bf16 v[28:31], v[48:51], a[204:207], v[28:31]
    buffer_load_dwordx4 v206, s[12:15], s40 offen offset:0 lds
    s_waitcnt lgkmcnt(8)
    v_mfma_f32_16x16x32_bf16 v[16:19], v[52:55], a[208:211], v[16:19]
    ds_read_b64_tr_b16 v[72:73], v196 offset:0
    v_mul_f32_e64 v47, v47, |v47|
    v_mfma_f32_16x16x32_bf16 v[20:23], v[52:55], a[212:215], v[20:23]
    ds_read_b64_tr_b16 v[74:75], v197 offset:0
    v_cvt_pk_bf16_f32 v139, v46, v47
    v_mfma_f32_16x16x32_bf16 v[24:27], v[52:55], a[216:219], v[24:27]
    buffer_load_dwordx4 v207, s[12:15], s40 offen offset:1024 lds
    v_pk_max_i16 v139, v139, 0
    v_mfma_f32_16x16x32_bf16 v[28:31], v[52:55], a[220:223], v[28:31]
    s_waitcnt lgkmcnt(8)
    v_mfma_f32_16x16x32_bf16 v[16:19], v[56:59], a[224:227], v[16:19]
    ds_read_b64_tr_b16 v[76:77], v196 offset:4096
    s_add_u32 m0, s31, 81920
    v_mfma_f32_16x16x32_bf16 v[20:23], v[56:59], a[228:231], v[20:23]
    ds_read_b64_tr_b16 v[78:79], v197 offset:4096
    buffer_load_dwordx4 v206, s[12:15], s41 offen offset:0 lds
    v_mfma_f32_16x16x32_bf16 v[24:27], v[56:59], a[232:235], v[24:27]
    v_mfma_f32_16x16x32_bf16 v[28:31], v[56:59], a[236:239], v[28:31]
    s_waitcnt lgkmcnt(8)
    v_mfma_f32_16x16x32_bf16 v[16:19], v[60:63], a[240:243], v[16:19]
    ds_read_b64_tr_b16 v[48:49], v196 offset:8192
    v_mfma_f32_16x16x32_bf16 v[20:23], v[60:63], a[244:247], v[20:23]
    ds_read_b64_tr_b16 v[50:51], v197 offset:8192
    buffer_load_dwordx4 v207, s[12:15], s41 offen offset:1024 lds
    v_mfma_f32_16x16x32_bf16 v[24:27], v[60:63], a[248:251], v[24:27]
    v_mfma_f32_16x16x32_bf16 v[28:31], v[60:63], a[252:255], v[28:31]
    s_waitcnt lgkmcnt(8)
    v_mfma_f32_16x16x32_bf16 v[16:19], v[64:67], v[164:167], v[16:19]
    ds_read_b64_tr_b16 v[52:53], v196 offset:12288
    s_add_u32 m0, s31, 90112
    v_mfma_f32_16x16x32_bf16 v[20:23], v[64:67], v[168:171], v[20:23]
    ds_read_b64_tr_b16 v[54:55], v197 offset:12288
    buffer_load_dwordx4 v206, s[12:15], s42 offen offset:0 lds
    v_mfma_f32_16x16x32_bf16 v[24:27], v[64:67], v[172:175], v[24:27]
    v_mfma_f32_16x16x32_bf16 v[28:31], v[64:67], v[176:179], v[28:31]
    s_waitcnt lgkmcnt(8)
    v_mfma_f32_16x16x32_bf16 v[16:19], v[68:71], v[180:183], v[16:19]
    ds_read_b64_tr_b16 v[56:57], v196 offset:16384
    v_mfma_f32_16x16x32_bf16 v[20:23], v[68:71], v[184:187], v[20:23]
    ds_read_b64_tr_b16 v[58:59], v197 offset:16384
    buffer_load_dwordx4 v207, s[12:15], s42 offen offset:1024 lds
    v_mfma_f32_16x16x32_bf16 v[24:27], v[68:71], v[188:191], v[24:27]
    v_mfma_f32_16x16x32_bf16 v[28:31], v[68:71], v[192:195], v[28:31]
    s_waitcnt vmcnt(12)
    s_barrier
    s_waitcnt lgkmcnt(8)
    v_mfma_f32_16x16x32_bf16 v[32:35], v[72:75], a[0:3], v[80:83]
    ds_read_b64_tr_b16 v[60:61], v196 offset:20480
    v_mfma_f32_16x16x32_bf16 v[36:39], v[72:75], a[4:7], v[80:83]
    ds_read_b64_tr_b16 v[62:63], v197 offset:20480
    s_add_u32 m0, s31, 98304
    v_mfma_f32_16x16x32_bf16 v[40:43], v[72:75], a[8:11], v[80:83]
    buffer_load_dwordx4 v206, s[12:15], s43 offen offset:0 lds
    v_mfma_f32_16x16x32_bf16 v[44:47], v[72:75], a[12:15], v[80:83]
    s_waitcnt lgkmcnt(8)
    v_mfma_f32_16x16x32_bf16 v[32:35], v[76:79], a[16:19], v[32:35]
    ds_read_b64_tr_b16 v[64:65], v196 offset:24576
    v_mul_f32_e64 v16, v16, |v16|
    v_mfma_f32_16x16x32_bf16 v[36:39], v[76:79], a[20:23], v[36:39]
    ds_read_b64_tr_b16 v[66:67], v197 offset:24576
    buffer_load_dwordx4 v207, s[12:15], s43 offen offset:1024 lds
    v_mfma_f32_16x16x32_bf16 v[40:43], v[76:79], a[24:27], v[40:43]
    v_mul_f32_e64 v17, v17, |v17|
    v_mfma_f32_16x16x32_bf16 v[44:47], v[76:79], a[28:31], v[44:47]
    v_cvt_pk_bf16_f32 v140, v16, v17
    s_waitcnt lgkmcnt(8)
    v_mfma_f32_16x16x32_bf16 v[32:35], v[48:51], a[32:35], v[32:35]
    ds_read_b64_tr_b16 v[68:69], v196 offset:28672
    s_add_u32 m0, s31, 106496
    v_mfma_f32_16x16x32_bf16 v[36:39], v[48:51], a[36:39], v[36:39]
    ds_read_b64_tr_b16 v[70:71], v197 offset:28672
    v_pk_max_i16 v140, v140, 0
    v_mfma_f32_16x16x32_bf16 v[40:43], v[48:51], a[40:43], v[40:43]
    buffer_load_dwordx4 v206, s[12:15], s44 offen offset:0 lds
    v_mul_f32_e64 v18, v18, |v18|
    v_mfma_f32_16x16x32_bf16 v[44:47], v[48:51], a[44:47], v[44:47]
    s_waitcnt lgkmcnt(8)
    v_mfma_f32_16x16x32_bf16 v[32:35], v[52:55], a[48:51], v[32:35]
    ds_read_b64_tr_b16 v[72:73], v196 offset:32768
    v_mul_f32_e64 v19, v19, |v19|
    v_mfma_f32_16x16x32_bf16 v[36:39], v[52:55], a[52:55], v[36:39]
    ds_read_b64_tr_b16 v[74:75], v197 offset:32768
    buffer_load_dwordx4 v207, s[12:15], s44 offen offset:1024 lds
    v_mfma_f32_16x16x32_bf16 v[40:43], v[52:55], a[56:59], v[40:43]
    v_cvt_pk_bf16_f32 v141, v18, v19
    v_mfma_f32_16x16x32_bf16 v[44:47], v[52:55], a[60:63], v[44:47]
    v_pk_max_i16 v141, v141, 0
    s_waitcnt lgkmcnt(8)
    v_mfma_f32_16x16x32_bf16 v[32:35], v[56:59], a[64:67], v[32:35]
    ds_read_b64_tr_b16 v[76:77], v196 offset:36864
    s_add_u32 m0, s31, 114688
    v_mfma_f32_16x16x32_bf16 v[36:39], v[56:59], a[68:71], v[36:39]
    ds_read_b64_tr_b16 v[78:79], v197 offset:36864
    buffer_load_dwordx4 v206, s[12:15], s45 offen offset:0 lds
    v_mfma_f32_16x16x32_bf16 v[40:43], v[56:59], a[72:75], v[40:43]
    v_mul_f32_e64 v20, v20, |v20|
    v_mul_f32_e64 v21, v21, |v21|
    v_mfma_f32_16x16x32_bf16 v[44:47], v[56:59], a[76:79], v[44:47]
    s_waitcnt lgkmcnt(8)
    v_mfma_f32_16x16x32_bf16 v[32:35], v[60:63], a[80:83], v[32:35]
    ds_read_b64_tr_b16 v[48:49], v196 offset:40960
    v_cvt_pk_bf16_f32 v144, v20, v21
    v_mfma_f32_16x16x32_bf16 v[36:39], v[60:63], a[84:87], v[36:39]
    ds_read_b64_tr_b16 v[50:51], v197 offset:40960
    buffer_load_dwordx4 v207, s[12:15], s45 offen offset:1024 lds
    v_mfma_f32_16x16x32_bf16 v[40:43], v[60:63], a[88:91], v[40:43]
    v_pk_max_i16 v144, v144, 0
    v_mfma_f32_16x16x32_bf16 v[44:47], v[60:63], a[92:95], v[44:47]
    v_mul_f32_e64 v22, v22, |v22|
    s_waitcnt vmcnt(12)
    s_barrier
    s_waitcnt lgkmcnt(8)
    v_mfma_f32_16x16x32_bf16 v[32:35], v[64:67], a[96:99], v[32:35]
    ds_read_b64_tr_b16 v[52:53], v196 offset:45056
    v_mfma_f32_16x16x32_bf16 v[36:39], v[64:67], a[100:103], v[36:39]
    ds_read_b64_tr_b16 v[54:55], v197 offset:45056
    s_add_u32 m0, s31, 122880
    v_mfma_f32_16x16x32_bf16 v[40:43], v[64:67], a[104:107], v[40:43]
    v_mul_f32_e64 v23, v23, |v23|
    buffer_load_dwordx4 v206, s[12:15], s46 offen offset:0 lds
    v_mfma_f32_16x16x32_bf16 v[44:47], v[64:67], a[108:111], v[44:47]
    v_cvt_pk_bf16_f32 v145, v22, v23
    s_waitcnt lgkmcnt(8)
    v_mfma_f32_16x16x32_bf16 v[32:35], v[68:71], a[112:115], v[32:35]
    ds_read_b64_tr_b16 v[56:57], v196 offset:49152
    v_pk_max_i16 v145, v145, 0
    v_mfma_f32_16x16x32_bf16 v[36:39], v[68:71], a[116:119], v[36:39]
    ds_read_b64_tr_b16 v[58:59], v197 offset:49152
    buffer_load_dwordx4 v207, s[12:15], s46 offen offset:1024 lds
    v_mfma_f32_16x16x32_bf16 v[40:43], v[68:71], a[120:123], v[40:43]
    v_mul_f32_e64 v24, v24, |v24|
    ds_read_b128 v[80:83], v220 offset:2048
    v_mfma_f32_16x16x32_bf16 v[44:47], v[68:71], a[124:127], v[44:47]
    v_mul_f32_e64 v25, v25, |v25|
    s_waitcnt lgkmcnt(9)
    v_mfma_f32_16x16x32_bf16 v[32:35], v[72:75], a[128:131], v[32:35]
    ds_read_b64_tr_b16 v[60:61], v196 offset:53248
    s_add_u32 m0, s31, 131072
    v_mfma_f32_16x16x32_bf16 v[36:39], v[72:75], a[132:135], v[36:39]
    ds_read_b64_tr_b16 v[62:63], v197 offset:53248
    buffer_load_dwordx4 v206, s[12:15], s47 offen offset:0 lds
    v_mfma_f32_16x16x32_bf16 v[40:43], v[72:75], a[136:139], v[40:43]
    v_cvt_pk_bf16_f32 v148, v24, v25
    v_pk_max_i16 v148, v148, 0
    v_mfma_f32_16x16x32_bf16 v[44:47], v[72:75], a[140:143], v[44:47]
    s_waitcnt lgkmcnt(9)
    v_mfma_f32_16x16x32_bf16 v[32:35], v[76:79], a[144:147], v[32:35]
    ds_read_b64_tr_b16 v[64:65], v196 offset:57344
    v_mul_f32_e64 v26, v26, |v26|
    v_mfma_f32_16x16x32_bf16 v[36:39], v[76:79], a[148:151], v[36:39]
    ds_read_b64_tr_b16 v[66:67], v197 offset:57344
    buffer_load_dwordx4 v207, s[12:15], s47 offen offset:1024 lds
    v_mfma_f32_16x16x32_bf16 v[40:43], v[76:79], a[152:155], v[40:43]
    v_mul_f32_e64 v27, v27, |v27|
    v_mfma_f32_16x16x32_bf16 v[44:47], v[76:79], a[156:159], v[44:47]
    v_cvt_pk_bf16_f32 v149, v26, v27
    s_waitcnt lgkmcnt(9)
    v_mfma_f32_16x16x32_bf16 v[32:35], v[48:51], a[160:163], v[32:35]
    ds_read_b64_tr_b16 v[68:69], v196 offset:61440
    s_add_u32 m0, s31, 139264
    v_mfma_f32_16x16x32_bf16 v[36:39], v[48:51], a[164:167], v[36:39]
    ds_read_b64_tr_b16 v[70:71], v197 offset:61440
    buffer_load_dwordx4 v206, s[12:15], s48 offen offset:0 lds
    v_mfma_f32_16x16x32_bf16 v[40:43], v[48:51], a[168:171], v[40:43]
    v_pk_max_i16 v149, v149, 0
    v_mfma_f32_16x16x32_bf16 v[44:47], v[48:51], a[172:175], v[44:47]
    v_mul_f32_e64 v28, v28, |v28|
    s_waitcnt lgkmcnt(9)
    v_mfma_f32_16x16x32_bf16 v[32:35], v[52:55], a[176:179], v[32:35]
    ds_read_b64_tr_b16 v[72:73], v198 offset:0
    v_mul_f32_e64 v29, v29, |v29|
    v_mfma_f32_16x16x32_bf16 v[36:39], v[52:55], a[180:183], v[36:39]
    ds_read_b64_tr_b16 v[74:75], v199 offset:0
    buffer_load_dwordx4 v207, s[12:15], s48 offen offset:1024 lds
    v_mfma_f32_16x16x32_bf16 v[40:43], v[52:55], a[184:187], v[40:43]
    v_cvt_pk_bf16_f32 v152, v28, v29
    v_mfma_f32_16x16x32_bf16 v[44:47], v[52:55], a[188:191], v[44:47]
    v_pk_max_i16 v152, v152, 0
    s_waitcnt vmcnt(12)
    s_barrier
    s_waitcnt lgkmcnt(9)
    v_mfma_f32_16x16x32_bf16 v[32:35], v[56:59], a[192:195], v[32:35]
    ds_read_b64_tr_b16 v[76:77], v198 offset:4096
    v_add_u32 v210, s67, v212
    v_mfma_f32_16x16x32_bf16 v[36:39], v[56:59], a[196:199], v[36:39]
    ds_read_b64_tr_b16 v[78:79], v199 offset:4096
    v_add_u32 v211, s67, v213
    v_mfma_f32_16x16x32_bf16 v[40:43], v[56:59], a[200:203], v[40:43]
    s_add_u32 m0, s31, 0
    v_mul_f32_e64 v30, v30, |v30|
    v_mfma_f32_16x16x32_bf16 v[44:47], v[56:59], a[204:207], v[44:47]
    buffer_load_dwordx4 v210, s[16:19], s49 offen offset:0 lds
    s_waitcnt lgkmcnt(8)
    v_mfma_f32_16x16x32_bf16 v[32:35], v[60:63], a[208:211], v[32:35]
    ds_read_b64_tr_b16 v[48:49], v198 offset:8192
    v_mul_f32_e64 v31, v31, |v31|
    v_mfma_f32_16x16x32_bf16 v[36:39], v[60:63], a[212:215], v[36:39]
    ds_read_b64_tr_b16 v[50:51], v199 offset:8192
    v_cvt_pk_bf16_f32 v153, v30, v31
    v_mfma_f32_16x16x32_bf16 v[40:43], v[60:63], a[216:219], v[40:43]
    buffer_load_dwordx4 v211, s[16:19], s49 offen offset:1024 lds
    v_pk_max_i16 v153, v153, 0
    v_mfma_f32_16x16x32_bf16 v[44:47], v[60:63], a[220:223], v[44:47]
    s_waitcnt lgkmcnt(8)
    v_mfma_f32_16x16x32_bf16 v[32:35], v[64:67], a[224:227], v[32:35]
    ds_read_b64_tr_b16 v[52:53], v198 offset:12288
    s_add_u32 m0, s31, 8192
    v_mfma_f32_16x16x32_bf16 v[36:39], v[64:67], a[228:231], v[36:39]
    ds_read_b64_tr_b16 v[54:55], v199 offset:12288
    buffer_load_dwordx4 v210, s[16:19], s50 offen offset:0 lds
    v_mfma_f32_16x16x32_bf16 v[40:43], v[64:67], a[232:235], v[40:43]
    v_mfma_f32_16x16x32_bf16 v[44:47], v[64:67], a[236:239], v[44:47]
    s_waitcnt lgkmcnt(8)
    v_mfma_f32_16x16x32_bf16 v[32:35], v[68:71], a[240:243], v[32:35]
    ds_read_b64_tr_b16 v[56:57], v198 offset:16384
    v_mfma_f32_16x16x32_bf16 v[36:39], v[68:71], a[244:247], v[36:39]
    ds_read_b64_tr_b16 v[58:59], v199 offset:16384
    buffer_load_dwordx4 v211, s[16:19], s50 offen offset:1024 lds
    v_mfma_f32_16x16x32_bf16 v[40:43], v[68:71], a[248:251], v[40:43]
    v_mfma_f32_16x16x32_bf16 v[44:47], v[68:71], a[252:255], v[44:47]
    s_waitcnt lgkmcnt(8)
    v_mfma_f32_16x16x32_bf16 v[32:35], v[72:75], v[164:167], v[32:35]
    ds_read_b64_tr_b16 v[60:61], v198 offset:20480
    s_add_u32 m0, s31, 16384
    v_mfma_f32_16x16x32_bf16 v[36:39], v[72:75], v[168:171], v[36:39]
    ds_read_b64_tr_b16 v[62:63], v199 offset:20480
    buffer_load_dwordx4 v210, s[16:19], s51 offen offset:0 lds
    v_mfma_f32_16x16x32_bf16 v[40:43], v[72:75], v[172:175], v[40:43]
    v_mfma_f32_16x16x32_bf16 v[44:47], v[72:75], v[176:179], v[44:47]
    s_waitcnt lgkmcnt(8)
    v_mfma_f32_16x16x32_bf16 v[32:35], v[76:79], v[180:183], v[32:35]
    ds_read_b64_tr_b16 v[64:65], v198 offset:24576
    v_mfma_f32_16x16x32_bf16 v[36:39], v[76:79], v[184:187], v[36:39]
    ds_read_b64_tr_b16 v[66:67], v199 offset:24576
    buffer_load_dwordx4 v211, s[16:19], s51 offen offset:1024 lds
    v_mfma_f32_16x16x32_bf16 v[40:43], v[76:79], v[188:191], v[40:43]
    v_mfma_f32_16x16x32_bf16 v[44:47], v[76:79], v[192:195], v[44:47]
    s_waitcnt vmcnt(12)
    s_barrier
    s_waitcnt lgkmcnt(8)
    v_mfma_f32_16x16x32_bf16 v[16:19], v[48:51], a[0:3], v[80:83]
    ds_read_b64_tr_b16 v[68:69], v198 offset:28672
    v_mfma_f32_16x16x32_bf16 v[20:23], v[48:51], a[4:7], v[80:83]
    ds_read_b64_tr_b16 v[70:71], v199 offset:28672
    s_add_u32 m0, s31, 24576
    v_mfma_f32_16x16x32_bf16 v[24:27], v[48:51], a[8:11], v[80:83]
    buffer_load_dwordx4 v210, s[16:19], s52 offen offset:0 lds
    v_mfma_f32_16x16x32_bf16 v[28:31], v[48:51], a[12:15], v[80:83]
    s_waitcnt lgkmcnt(8)
    v_mfma_f32_16x16x32_bf16 v[16:19], v[52:55], a[16:19], v[16:19]
    ds_read_b64_tr_b16 v[72:73], v198 offset:32768
    v_mul_f32_e64 v32, v32, |v32|
    v_mfma_f32_16x16x32_bf16 v[20:23], v[52:55], a[20:23], v[20:23]
    ds_read_b64_tr_b16 v[74:75], v199 offset:32768
    buffer_load_dwordx4 v211, s[16:19], s52 offen offset:1024 lds
    v_mfma_f32_16x16x32_bf16 v[24:27], v[52:55], a[24:27], v[24:27]
    v_mul_f32_e64 v33, v33, |v33|
    v_mfma_f32_16x16x32_bf16 v[28:31], v[52:55], a[28:31], v[28:31]
    v_cvt_pk_bf16_f32 v142, v32, v33
    s_waitcnt lgkmcnt(8)
    v_mfma_f32_16x16x32_bf16 v[16:19], v[56:59], a[32:35], v[16:19]
    ds_read_b64_tr_b16 v[76:77], v198 offset:36864
    s_add_u32 m0, s31, 32768
    v_mfma_f32_16x16x32_bf16 v[20:23], v[56:59], a[36:39], v[20:23]
    ds_read_b64_tr_b16 v[78:79], v199 offset:36864
    v_pk_max_i16 v142, v142, 0
    v_mfma_f32_16x16x32_bf16 v[24:27], v[56:59], a[40:43], v[24:27]
    buffer_load_dwordx4 v210, s[16:19], s53 offen offset:0 lds
    v_mul_f32_e64 v34, v34, |v34|
    v_mfma_f32_16x16x32_bf16 v[28:31], v[56:59], a[44:47], v[28:31]
    s_waitcnt lgkmcnt(8)
    v_mfma_f32_16x16x32_bf16 v[16:19], v[60:63], a[48:51], v[16:19]
    ds_read_b64_tr_b16 v[48:49], v198 offset:40960
    v_mul_f32_e64 v35, v35, |v35|
    v_mfma_f32_16x16x32_bf16 v[20:23], v[60:63], a[52:55], v[20:23]
    ds_read_b64_tr_b16 v[50:51], v199 offset:40960
    buffer_load_dwordx4 v211, s[16:19], s53 offen offset:1024 lds
    v_mfma_f32_16x16x32_bf16 v[24:27], v[60:63], a[56:59], v[24:27]
    v_cvt_pk_bf16_f32 v143, v34, v35
    v_mfma_f32_16x16x32_bf16 v[28:31], v[60:63], a[60:63], v[28:31]
    v_pk_max_i16 v143, v143, 0
    s_waitcnt lgkmcnt(8)
    v_mfma_f32_16x16x32_bf16 v[16:19], v[64:67], a[64:67], v[16:19]
    ds_read_b64_tr_b16 v[52:53], v198 offset:45056
    s_add_u32 m0, s31, 40960
    v_mfma_f32_16x16x32_bf16 v[20:23], v[64:67], a[68:71], v[20:23]
    ds_read_b64_tr_b16 v[54:55], v199 offset:45056
    buffer_load_dwordx4 v210, s[16:19], s54 offen offset:0 lds
    v_mfma_f32_16x16x32_bf16 v[24:27], v[64:67], a[72:75], v[24:27]
    v_mul_f32_e64 v36, v36, |v36|
    v_mul_f32_e64 v37, v37, |v37|
    v_mfma_f32_16x16x32_bf16 v[28:31], v[64:67], a[76:79], v[28:31]
    s_waitcnt lgkmcnt(8)
    v_mfma_f32_16x16x32_bf16 v[16:19], v[68:71], a[80:83], v[16:19]
    ds_read_b64_tr_b16 v[56:57], v198 offset:49152
    v_cvt_pk_bf16_f32 v146, v36, v37
    v_mfma_f32_16x16x32_bf16 v[20:23], v[68:71], a[84:87], v[20:23]
    ds_read_b64_tr_b16 v[58:59], v199 offset:49152
    buffer_load_dwordx4 v211, s[16:19], s54 offen offset:1024 lds
    v_mfma_f32_16x16x32_bf16 v[24:27], v[68:71], a[88:91], v[24:27]
    v_pk_max_i16 v146, v146, 0
    v_mfma_f32_16x16x32_bf16 v[28:31], v[68:71], a[92:95], v[28:31]
    v_mul_f32_e64 v38, v38, |v38|
    s_waitcnt vmcnt(12)
    s_barrier
    s_waitcnt lgkmcnt(8)
    v_mfma_f32_16x16x32_bf16 v[16:19], v[72:75], a[96:99], v[16:19]
    ds_read_b64_tr_b16 v[60:61], v198 offset:53248
    v_mfma_f32_16x16x32_bf16 v[20:23], v[72:75], a[100:103], v[20:23]
    ds_read_b64_tr_b16 v[62:63], v199 offset:53248
    s_add_u32 m0, s31, 49152
    v_mfma_f32_16x16x32_bf16 v[24:27], v[72:75], a[104:107], v[24:27]
    v_mul_f32_e64 v39, v39, |v39|
    buffer_load_dwordx4 v210, s[16:19], s55 offen offset:0 lds
    v_mfma_f32_16x16x32_bf16 v[28:31], v[72:75], a[108:111], v[28:31]
    v_cvt_pk_bf16_f32 v147, v38, v39
    s_waitcnt lgkmcnt(8)
    v_mfma_f32_16x16x32_bf16 v[16:19], v[76:79], a[112:115], v[16:19]
    ds_read_b64_tr_b16 v[64:65], v198 offset:57344
    v_pk_max_i16 v147, v147, 0
    v_mfma_f32_16x16x32_bf16 v[20:23], v[76:79], a[116:119], v[20:23]
    ds_read_b64_tr_b16 v[66:67], v199 offset:57344
    buffer_load_dwordx4 v211, s[16:19], s55 offen offset:1024 lds
    v_mfma_f32_16x16x32_bf16 v[24:27], v[76:79], a[120:123], v[24:27]
    v_mul_f32_e64 v40, v40, |v40|
    v_mfma_f32_16x16x32_bf16 v[28:31], v[76:79], a[124:127], v[28:31]
    v_mul_f32_e64 v41, v41, |v41|
    s_waitcnt lgkmcnt(8)
    v_mfma_f32_16x16x32_bf16 v[16:19], v[48:51], a[128:131], v[16:19]
L_pg9:
    s_cbranch_vccnz L_pg13
    ds_read_b64_tr_b16 v[68:69], v198 offset:61440
    s_add_u32 m0, s31, 57344
    v_mfma_f32_16x16x32_bf16 v[20:23], v[48:51], a[132:135], v[20:23]
    ds_read_b64_tr_b16 v[70:71], v199 offset:61440
    buffer_load_dwordx4 v210, s[16:19], s56 offen offset:0 lds
    v_mfma_f32_16x16x32_bf16 v[24:27], v[48:51], a[136:139], v[24:27]
    v_cvt_pk_bf16_f32 v150, v40, v41
L_pg10:
    s_cbranch_vccnz L_pg14
    v_pk_max_i16 v150, v150, 0
    v_mfma_f32_16x16x32_bf16 v[28:31], v[48:51], a[140:143], v[28:31]
    s_waitcnt lgkmcnt(8)
    v_mfma_f32_16x16x32_bf16 v[16:19], v[52:55], a[144:147], v[16:19]
    ds_read_b64_tr_b16 v[72:73], v200 offset:0
    v_mul_f32_e64 v42, v42, |v42|
    v_mfma_f32_16x16x32_bf16 v[20:23], v[52:55], a[148:151], v[20:23]
    ds_read_b64_tr_b16 v[74:75], v201 offset:0
L_pg11:
    s_cbranch_vccnz L_pg15
    buffer_load_dwordx4 v211, s[16:19], s56 offen offset:1024 lds
    v_mfma_f32_16x16x32_bf16 v[24:27], v[52:55], a[152:155], v[24:27]
    v_mul_f32_e64 v43, v43, |v43|
    v_mfma_f32_16x16x32_bf16 v[28:31], v[52:55], a[156:159], v[28:31]
    v_cvt_pk_bf16_f32 v151, v42, v43
    s_waitcnt lgkmcnt(8)
    v_mfma_f32_16x16x32_bf16 v[16:19], v[56:59], a[160:163], v[16:19]
    ds_read_b64_tr_b16 v[76:77], v200 offset:4096
    s_add_u32 m0, s31, 65536
    v_mfma_f32_16x16x32_bf16 v[20:23], v[56:59], a[164:167], v[20:23]
    ds_read_b64_tr_b16 v[78:79], v201 offset:4096
    buffer_load_dwordx4 v210, s[16:19], s57 offen offset:0 lds
    v_mfma_f32_16x16x32_bf16 v[24:27], v[56:59], a[168:171], v[24:27]
    v_pk_max_i16 v151, v151, 0
    v_mfma_f32_16x16x32_bf16 v[28:31], v[56:59], a[172:175], v[28:31]
    v_mul_f32_e64 v44, v44, |v44|
    s_waitcnt lgkmcnt(8)
    v_mfma_f32_16x16x32_bf16 v[16:19], v[60:63], a[176:179], v[16:19]
    ds_read_b64_tr_b16 v[48:49], v200 offset:8192
    v_mul_f32_e64 v45, v45, |v45|
    v_mfma_f32_16x16x32_bf16 v[20:23], v[60:63], a[180:183], v[20:23]
    ds_read_b64_tr_b16 v[50:51], v201 offset:8192
    buffer_load_dwordx4 v211, s[16:19], s57 offen offset:1024 lds
    v_mfma_f32_16x16x32_bf16 v[24:27], v[60:63], a[184:187], v[24:27]
    v_cvt_pk_bf16_f32 v154, v44, v45
    v_mfma_f32_16x16x32_bf16 v[28:31], v[60:63], a[188:191], v[28:31]
    v_pk_max_i16 v154, v154, 0
    s_waitcnt vmcnt(12)
    s_barrier
    s_waitcnt lgkmcnt(8)
    v_mfma_f32_16x16x32_bf16 v[16:19], v[64:67], a[192:195], v[16:19]
    ds_read_b64_tr_b16 v[52:53], v200 offset:12288
    v_add_u32 v210, s68, v212
    v_mfma_f32_16x16x32_bf16 v[20:23], v[64:67], a[196:199], v[20:23]
    ds_read_b64_tr_b16 v[54:55], v201 offset:12288
    v_add_u32 v211, s68, v213
    v_mfma_f32_16x16x32_bf16 v[24:27], v[64:67], a[200:203], v[24:27]
    s_add_u32 m0, s31, 73728
    v_mul_f32_e64 v46, v46, |v46|
    v_mfma_f32_16x16x32_bf16 v[28:31], v[64:67], a[204:207], v[28:31]
    buffer_load_dwordx4 v210, s[16:19], s49 offen offset:0 lds
    s_waitcnt lgkmcnt(8)
    v_mfma_f32_16x16x32_bf16 v[16:19], v[68:71], a[208:211], v[16:19]
    v_mul_f32_e64 v47, v47, |v47|
    v_mfma_f32_16x16x32_bf16 v[20:23], v[68:71], a[212:215], v[20:23]
    v_cvt_pk_bf16_f32 v155, v46, v47
    v_mfma_f32_16x16x32_bf16 v[24:27], v[68:71], a[216:219], v[24:27]
    buffer_load_dwordx4 v211, s[16:19], s49 offen offset:1024 lds
    v_pk_max_i16 v155, v155, 0
    v_mfma_f32_16x16x32_bf16 v[28:31], v[68:71], a[220:223], v[28:31]
    s_waitcnt lgkmcnt(6)
    v_mfma_f32_16x16x32_bf16 v[16:19], v[72:75], a[224:227], v[16:19]
    s_add_u32 m0, s31, 81920
    v_mfma_f32_16x16x32_bf16 v[20:23], v[72:75], a[228:231], v[20:23]
    buffer_load_dwordx4 v210, s[16:19], s50 offen offset:0 lds
    v_mfma_f32_16x16x32_bf16 v[24:27], v[72:75], a[232:235], v[24:27]
    v_mfma_f32_16x16x32_bf16 v[28:31], v[72:75], a[236:239], v[28:31]
    s_waitcnt lgkmcnt(4)
    v_mfma_f32_16x16x32_bf16 v[16:19], v[76:79], a[240:243], v[16:19]
    v_mfma_f32_16x16x32_bf16 v[20:23], v[76:79], a[244:247], v[20:23]
    buffer_load_dwordx4 v211, s[16:19], s50 offen offset:1024 lds
    v_mfma_f32_16x16x32_bf16 v[24:27], v[76:79], a[248:251], v[24:27]
    v_mfma_f32_16x16x32_bf16 v[28:31], v[76:79], a[252:255], v[28:31]
    s_waitcnt lgkmcnt(2)
    v_mfma_f32_16x16x32_bf16 v[16:19], v[48:51], v[164:167], v[16:19]
    s_add_u32 m0, s31, 90112
    v_mfma_f32_16x16x32_bf16 v[20:23], v[48:51], v[168:171], v[20:23]
    buffer_load_dwordx4 v210, s[16:19], s51 offen offset:0 lds
    v_mfma_f32_16x16x32_bf16 v[24:27], v[48:51], v[172:175], v[24:27]
    v_mfma_f32_16x16x32_bf16 v[28:31], v[48:51], v[176:179], v[28:31]
    s_waitcnt lgkmcnt(0)
    v_mfma_f32_16x16x32_bf16 v[16:19], v[52:55], v[180:183], v[16:19]
    v_mfma_f32_16x16x32_bf16 v[20:23], v[52:55], v[184:187], v[20:23]
    buffer_load_dwordx4 v211, s[16:19], s51 offen offset:1024 lds
    v_mfma_f32_16x16x32_bf16 v[24:27], v[52:55], v[188:191], v[24:27]
    v_mfma_f32_16x16x32_bf16 v[28:31], v[52:55], v[192:195], v[28:31]
    s_waitcnt vmcnt(12)
    s_barrier
    ds_write_b128 v248, v[92:95] offset:0
    ds_write_b128 v248, v[96:99] offset:1024
    ds_write_b128 v248, v[100:103] offset:2048
    ds_write_b128 v248, v[104:107] offset:3072
    ds_write_b64 v218, v[108:109] offset:16384
    ds_write_b64 v218, v[110:111] offset:17408
    ds_write_b64 v218, v[112:113] offset:18432
    ds_write_b64 v218, v[114:115] offset:19456
    ds_write_b128 v248, v[116:119] offset:24576
    ds_write_b128 v248, v[120:123] offset:25600
    ds_write_b128 v248, v[124:127] offset:26624
    ds_write_b128 v248, v[128:131] offset:27648
    s_waitcnt lgkmcnt(0)
    s_barrier
    ds_read_b64_tr_b16 v[56:57], v214 offset:0
    ds_read_b64_tr_b16 v[58:59], v214 offset:8192
    ds_read_b128 a[0:3], v249 offset:0
    ds_read_b128 a[4:7], v249 offset:1024
    ds_read_b128 a[8:11], v249 offset:2048
    ds_read_b128 a[12:15], v249 offset:3072
    s_waitcnt lgkmcnt(4)
    v_mfma_f32_16x16x32_bf16 v[32:35], v[56:59], v[92:95], 0
    ds_read_b64_tr_b16 v[60:61], v217 offset:0
    ds_read_b128 a[16:19], v250 offset:0
    v_mfma_f32_16x16x32_bf16 v[36:39], v[56:59], v[96:99], 0
    ds_read_b64_tr_b16 v[62:63], v217 offset:8192
    ds_read_b128 a[20:23], v250 offset:1024
    s_add_u32 m0, s31, 98304
    v_mfma_f32_16x16x32_bf16 v[40:43], v[56:59], v[100:103], 0
    ds_read_b128 a[24:27], v250 offset:2048
    buffer_load_dwordx4 v210, s[16:19], s52 offen offset:0 lds
    v_mfma_f32_16x16x32_bf16 v[44:47], v[56:59], v[104:107], 0
    ds_read_b128 a[28:31], v250 offset:3072
    s_waitcnt lgkmcnt(3)
    v_mfma_f32_16x16x32_bf16 v[32:35], v[60:63], a[0:3], v[32:35]
    ds_read_b64_tr_b16 v[64:65], v224 offset:0
    ds_read_b128 a[32:35], v251 offset:0
    v_mul_f32_e64 v16, v16, |v16|
    v_mfma_f32_16x16x32_bf16 v[36:39], v[60:63], a[4:7], v[36:39]
    ds_read_b64_tr_b16 v[66:67], v224 offset:8192
    ds_read_b128 a[36:39], v251 offset:1024
    buffer_load_dwordx4 v211, s[16:19], s52 offen offset:1024 lds
    v_mfma_f32_16x16x32_bf16 v[40:43], v[60:63], a[8:11], v[40:43]
    ds_read_b128 a[40:43], v251 offset:2048
    v_mul_f32_e64 v17, v17, |v17|
    v_cvt_pk_bf16_f32 v156, v16, v17
    v_mfma_f32_16x16x32_bf16 v[44:47], v[60:63], a[12:15], v[44:47]
    ds_read_b128 a[44:47], v251 offset:3072
    v_pk_max_i16 v156, v156, 0
    s_waitcnt lgkmcnt(3)
    v_mfma_f32_16x16x32_bf16 v[32:35], v[64:67], a[16:19], v[32:35]
    ds_read_b64_tr_b16 v[68:69], v227 offset:0
    ds_read_b128 a[48:51], v219 offset:16384
    s_add_u32 m0, s31, 106496
    v_mfma_f32_16x16x32_bf16 v[36:39], v[64:67], a[20:23], v[36:39]
    ds_read_b64_tr_b16 v[70:71], v227 offset:8192
    ds_read_b128 a[52:55], v219 offset:17408
    buffer_load_dwordx4 v210, s[16:19], s53 offen offset:0 lds
    v_mfma_f32_16x16x32_bf16 v[40:43], v[64:67], a[24:27], v[40:43]
    ds_read_b128 a[56:59], v219 offset:18432
    v_mul_f32_e64 v18, v18, |v18|
    v_mul_f32_e64 v19, v19, |v19|
    v_mfma_f32_16x16x32_bf16 v[44:47], v[64:67], a[28:31], v[44:47]
    ds_read_b128 a[60:63], v219 offset:19456
    v_cvt_pk_bf16_f32 v157, v18, v19
    s_waitcnt lgkmcnt(3)
    v_mfma_f32_16x16x32_bf16 v[32:35], v[68:71], a[32:35], v[32:35]
    ds_read_b64_tr_b16 v[72:73], v202 offset:16384
    ds_read_b128 a[64:67], v219 offset:20480
    v_mfma_f32_16x16x32_bf16 v[36:39], v[68:71], a[36:39], v[36:39]
    ds_read_b64_tr_b16 v[74:75], v202 offset:18432
    ds_read_b128 a[68:71], v219 offset:21504
    buffer_load_dwordx4 v211, s[16:19], s53 offen offset:1024 lds
    v_mfma_f32_16x16x32_bf16 v[40:43], v[68:71], a[40:43], v[40:43]
    ds_read_b128 a[72:75], v219 offset:22528
    v_pk_max_i16 v157, v157, 0
    v_mul_f32_e64 v20, v20, |v20|
    v_mfma_f32_16x16x32_bf16 v[44:47], v[68:71], a[44:47], v[44:47]
    ds_read_b128 a[76:79], v219 offset:23552
    v_mul_f32_e64 v21, v21, |v21|
    s_waitcnt lgkmcnt(3)
    v_mfma_f32_16x16x32_bf16 v[32:35], v[72:75], a[48:51], v[32:35]
    ds_read_b64_tr_b16 v[76:77], v202 offset:20480
    s_add_u32 m0, s31, 114688
    v_mfma_f32_16x16x32_bf16 v[36:39], v[72:75], a[52:55], v[36:39]
    ds_read_b64_tr_b16 v[78:79], v202 offset:22528
    buffer_load_dwordx4 v210, s[16:19], s54 offen offset:0 lds
    v_mfma_f32_16x16x32_bf16 v[40:43], v[72:75], a[56:59], v[40:43]
    v_cvt_pk_bf16_f32 v158, v20, v21
    v_pk_max_i16 v158, v158, 0
    v_mfma_f32_16x16x32_bf16 v[44:47], v[72:75], a[60:63], v[44:47]
    v_mul_f32_e64 v22, v22, |v22|
    s_waitcnt lgkmcnt(0)
    v_mfma_f32_16x16x32_bf16 v[32:35], v[76:79], a[64:67], v[32:35]
    ds_read_b64_tr_b16 v[48:49], v214 offset:24576
    v_mfma_f32_16x16x32_bf16 v[36:39], v[76:79], a[68:71], v[36:39]
    ds_read_b64_tr_b16 v[50:51], v214 offset:32768
    buffer_load_dwordx4 v211, s[16:19], s54 offen offset:1024 lds
    v_mfma_f32_16x16x32_bf16 v[40:43], v[76:79], a[72:75], v[40:43]
    v_mul_f32_e64 v23, v23, |v23|
    v_cvt_pk_bf16_f32 v159, v22, v23
    v_mfma_f32_16x16x32_bf16 v[44:47], v[76:79], a[76:79], v[44:47]
    v_pk_max_i16 v159, v159, 0
    s_waitcnt vmcnt(12)
    s_barrier
    ds_write_b64 v218, v[132:133] offset:16384
    ds_write_b64 v218, v[134:135] offset:17408
    ds_write_b64 v218, v[136:137] offset:18432
    ds_write_b64 v218, v[138:139] offset:19456
    ds_read_b128 a[80:83], v249 offset:24576
    ds_read_b128 a[84:87], v249 offset:25600
    ds_read_b128 a[88:91], v249 offset:26624
    ds_read_b128 a[92:95], v249 offset:27648
    s_waitcnt lgkmcnt(8)
    v_mfma_f32_16x16x32_bf16 v[32:35], v[48:51], v[116:119], v[32:35]
    ds_read_b64_tr_b16 v[52:53], v217 offset:24576
    ds_read_b128 a[96:99], v250 offset:24576
    v_mfma_f32_16x16x32_bf16 v[36:39], v[48:51], v[120:123], v[36:39]
    ds_read_b64_tr_b16 v[54:55], v217 offset:32768
    ds_read_b128 a[100:103], v250 offset:25600
    s_add_u32 m0, s31, 0
    v_mfma_f32_16x16x32_bf16 v[40:43], v[48:51], v[124:127], v[40:43]
    ds_read_b128 a[104:107], v250 offset:26624
    v_mul_f32_e64 v24, v24, |v24|
    buffer_load_dwordx4 v210, s[16:19], s55 offen offset:0 lds
    v_mfma_f32_16x16x32_bf16 v[44:47], v[48:51], v[128:131], v[44:47]
    ds_read_b128 a[108:111], v250 offset:27648
    v_mul_f32_e64 v25, v25, |v25|
    s_waitcnt lgkmcnt(3)
    v_mfma_f32_16x16x32_bf16 v[32:35], v[52:55], a[80:83], v[32:35]
    ds_read_b64_tr_b16 v[56:57], v224 offset:24576
    ds_read_b128 a[112:115], v251 offset:24576
    v_cvt_pk_bf16_f32 v160, v24, v25
    v_mfma_f32_16x16x32_bf16 v[36:39], v[52:55], a[84:87], v[36:39]
    ds_read_b64_tr_b16 v[58:59], v224 offset:32768
    ds_read_b128 a[116:119], v251 offset:25600
    v_pk_max_i16 v160, v160, 0
    v_mfma_f32_16x16x32_bf16 v[40:43], v[52:55], a[88:91], v[40:43]
    ds_read_b128 a[120:123], v251 offset:26624
    buffer_load_dwordx4 v211, s[16:19], s55 offen offset:1024 lds
    v_mul_f32_e64 v26, v26, |v26|
    v_mfma_f32_16x16x32_bf16 v[44:47], v[52:55], a[92:95], v[44:47]
    ds_read_b128 a[124:127], v251 offset:27648
    v_mul_f32_e64 v27, v27, |v27|
    s_barrier
    s_waitcnt lgkmcnt(3)
    v_mfma_f32_16x16x32_bf16 v[32:35], v[56:59], a[96:99], v[32:35]
    ds_read_b64_tr_b16 v[60:61], v227 offset:24576
    ds_read_b128 a[128:131], v219 offset:16384
    s_add_u32 m0, s31, 8192
    v_mfma_f32_16x16x32_bf16 v[36:39], v[56:59], a[100:103], v[36:39]
    ds_read_b64_tr_b16 v[62:63], v227 offset:32768
    ds_read_b128 a[132:135], v219 offset:17408
    v_cvt_pk_bf16_f32 v161, v26, v27
    v_mfma_f32_16x16x32_bf16 v[40:43], v[56:59], a[104:107], v[40:43]
    ds_read_b128 a[136:139], v219 offset:18432
    buffer_load_dwordx4 v210, s[16:19], s56 offen offset:0 lds
    v_pk_max_i16 v161, v161, 0
    v_mfma_f32_16x16x32_bf16 v[44:47], v[56:59], a[108:111], v[44:47]
    ds_read_b128 a[140:143], v219 offset:19456
    v_mul_f32_e64 v28, v28, |v28|
    s_waitcnt lgkmcnt(3)
    v_mfma_f32_16x16x32_bf16 v[32:35], v[60:63], a[112:115], v[32:35]
    ds_read_b64_tr_b16 v[64:65], v202 offset:40960
    ds_read_b128 a[144:147], v219 offset:20480
    v_mul_f32_e64 v29, v29, |v29|
    v_mfma_f32_16x16x32_bf16 v[36:39], v[60:63], a[116:119], v[36:39]
    ds_read_b64_tr_b16 v[66:67], v202 offset:43008
    ds_read_b128 a[148:151], v219 offset:21504
    buffer_load_dwordx4 v211, s[16:19], s56 offen offset:1024 lds
    v_mfma_f32_16x16x32_bf16 v[40:43], v[60:63], a[120:123], v[40:43]
    ds_read_b128 a[152:155], v219 offset:22528
    v_cvt_pk_bf16_f32 v162, v28, v29
    v_mfma_f32_16x16x32_bf16 v[44:47], v[60:63], a[124:127], v[44:47]
    ds_read_b128 a[156:159], v219 offset:23552
    v_pk_max_i16 v162, v162, 0
    s_waitcnt lgkmcnt(3)
    v_mfma_f32_16x16x32_bf16 v[32:35], v[64:67], a[128:131], v[32:35]
    ds_read_b64_tr_b16 v[68:69], v202 offset:45056
    ds_write_b128 v248, v[140:143] offset:0
    s_add_u32 m0, s31, 16384
    v_mfma_f32_16x16x32_bf16 v[36:39], v[64:67], a[132:135], v[36:39]
    ds_read_b64_tr_b16 v[70:71], v202 offset:47104
    ds_write_b128 v248, v[144:147] offset:1024
    v_mul_f32_e64 v30, v30, |v30|
    v_mfma_f32_16x16x32_bf16 v[40:43], v[64:67], a[136:139], v[40:43]
    ds_write_b128 v248, v[148:151] offset:2048
    buffer_load_dwordx4 v210, s[16:19], s57 offen offset:0 lds
    v_mul_f32_e64 v31, v31, |v31|
    v_mfma_f32_16x16x32_bf16 v[44:47], v[64:67], a[140:143], v[44:47]
    ds_write_b128 v248, v[152:155] offset:3072
    v_cvt_pk_bf16_f32 v163, v30, v31
    s_waitcnt lgkmcnt(3)
    v_mfma_f32_16x16x32_bf16 v[32:35], v[68:71], a[144:147], v[32:35]
    ds_read_b64_tr_b16 v[72:73], v214 offset:49152
    v_pk_max_i16 v163, v163, 0
    v_mfma_f32_16x16x32_bf16 v[36:39], v[68:71], a[148:151], v[36:39]
    ds_read_b64_tr_b16 v[74:75], v214 offset:57344
    buffer_load_dwordx4 v211, s[16:19], s57 offen offset:1024 lds
    v_mfma_f32_16x16x32_bf16 v[40:43], v[68:71], a[152:155], v[40:43]
    buffer_load_dword v244, v243, s[4:7], 0 offen sc1
    v_mfma_f32_16x16x32_bf16 v[44:47], v[68:71], a[156:159], v[44:47]
    s_waitcnt lgkmcnt(2)
    s_waitcnt vmcnt(13)
    s_barrier
    ds_write_b64 v218, v[156:157] offset:16384
    ds_write_b64 v218, v[158:159] offset:17408
    ds_write_b64 v218, v[160:161] offset:18432
    ds_write_b64 v218, v[162:163] offset:19456
    ds_read_b128 a[160:163], v249 offset:0
    ds_read_b128 a[164:167], v249 offset:1024
    ds_read_b128 a[168:171], v249 offset:2048
    ds_read_b128 a[172:175], v249 offset:3072
    s_waitcnt lgkmcnt(8)
    v_mfma_f32_16x16x32_bf16 v[32:35], v[72:75], v[140:143], v[32:35]
    ds_read_b64_tr_b16 v[76:77], v217 offset:49152
    ds_read_b128 a[176:179], v250 offset:0
    v_add_u32 v210, s69, v212
    v_mfma_f32_16x16x32_bf16 v[36:39], v[72:75], v[144:147], v[36:39]
    ds_read_b64_tr_b16 v[78:79], v217 offset:57344
    ds_read_b128 a[180:183], v250 offset:1024
    v_add_u32 v211, s69, v213
    v_mfma_f32_16x16x32_bf16 v[40:43], v[72:75], v[148:151], v[40:43]
    ds_read_b128 a[184:187], v250 offset:2048
    s_add_u32 m0, s31, 24576
    s_nop 0
    buffer_load_dwordx4 v210, s[16:19], s49 offen offset:0 lds
    v_mfma_f32_16x16x32_bf16 v[44:47], v[72:75], v[152:155], v[44:47]
    ds_read_b128 a[188:191], v250 offset:3072
    s_waitcnt lgkmcnt(3)
    v_mfma_f32_16x16x32_bf16 v[32:35], v[76:79], a[160:163], v[32:35]
    ds_read_b64_tr_b16 v[48:49], v224 offset:49152
    ds_read_b128 a[192:195], v251 offset:0
    v_mfma_f32_16x16x32_bf16 v[36:39], v[76:79], a[164:167], v[36:39]
    ds_read_b64_tr_b16 v[50:51], v224 offset:57344
    ds_read_b128 a[196:199], v251 offset:1024
    buffer_load_dwordx4 v211, s[16:19], s49 offen offset:1024 lds
    v_mfma_f32_16x16x32_bf16 v[40:43], v[76:79], a[168:171], v[40:43]
    ds_read_b128 a[200:203], v251 offset:2048
    v_mfma_f32_16x16x32_bf16 v[44:47], v[76:79], a[172:175], v[44:47]
    ds_read_b128 a[204:207], v251 offset:3072
    s_barrier
    s_waitcnt lgkmcnt(3)
    v_mfma_f32_16x16x32_bf16 v[32:35], v[48:51], a[176:179], v[32:35]
    ds_read_b64_tr_b16 v[52:53], v227 offset:49152
    ds_read_b128 a[208:211], v219 offset:16384
    s_add_u32 m0, s31, 32768
    v_mfma_f32_16x16x32_bf16 v[36:39], v[48:51], a[180:183], v[36:39]
    ds_read_b64_tr_b16 v[54:55], v227 offset:57344
    ds_read_b128 a[212:215], v219 offset:17408
    buffer_load_dwordx4 v210, s[16:19], s50 offen offset:0 lds
    v_mfma_f32_16x16x32_bf16 v[40:43], v[48:51], a[184:187], v[40:43]
    ds_read_b128 a[216:219], v219 offset:18432
    v_mfma_f32_16x16x32_bf16 v[44:47], v[48:51], a[188:191], v[44:47]
    ds_read_b128 a[220:223], v219 offset:19456
    s_waitcnt lgkmcnt(3)
    v_mfma_f32_16x16x32_bf16 v[32:35], v[52:55], a[192:195], v[32:35]
    ds_read_b64_tr_b16 v[56:57], v203 offset:0
    ds_read_b128 a[224:227], v219 offset:20480
    v_mfma_f32_16x16x32_bf16 v[36:39], v[52:55], a[196:199], v[36:39]
    ds_read_b64_tr_b16 v[58:59], v203 offset:2048
    ds_read_b128 a[228:231], v219 offset:21504
    buffer_load_dwordx4 v211, s[16:19], s50 offen offset:1024 lds
    v_mfma_f32_16x16x32_bf16 v[40:43], v[52:55], a[200:203], v[40:43]
    ds_read_b128 a[232:235], v219 offset:22528
    v_mfma_f32_16x16x32_bf16 v[44:47], v[52:55], a[204:207], v[44:47]
    ds_read_b128 a[236:239], v219 offset:23552
    s_waitcnt lgkmcnt(3)
    v_mfma_f32_16x16x32_bf16 v[32:35], v[56:59], a[208:211], v[32:35]
    ds_read_b64_tr_b16 v[60:61], v203 offset:4096
    s_add_u32 m0, s31, 40960
    v_mfma_f32_16x16x32_bf16 v[36:39], v[56:59], a[212:215], v[36:39]
    ds_read_b64_tr_b16 v[62:63], v203 offset:6144
    buffer_load_dwordx4 v210, s[16:19], s51 offen offset:0 lds
    v_mfma_f32_16x16x32_bf16 v[40:43], v[56:59], a[216:219], v[40:43]
    v_mfma_f32_16x16x32_bf16 v[44:47], v[56:59], a[220:223], v[44:47]
    s_waitcnt lgkmcnt(0)
    v_mfma_f32_16x16x32_bf16 v[32:35], v[60:63], a[224:227], v[32:35]
    ds_read_b64_tr_b16 v[64:65], v215 offset:8192
    v_mfma_f32_16x16x32_bf16 v[36:39], v[60:63], a[228:231], v[36:39]
    ds_read_b64_tr_b16 v[66:67], v215 offset:16384
    buffer_load_dwordx4 v211, s[16:19], s51 offen offset:1024 lds
    v_mfma_f32_16x16x32_bf16 v[40:43], v[60:63], a[232:235], v[40:43]
    v_mfma_f32_16x16x32_bf16 v[44:47], v[60:63], a[236:239], v[44:47]
    s_waitcnt vmcnt(13)
    s_barrier
    s_waitcnt lgkmcnt(0)
    v_mfma_f32_16x16x32_bf16 v[16:19], v[64:67], v[92:95], 0
    ds_read_b64_tr_b16 v[68:69], v222 offset:8192
    v_mfma_f32_16x16x32_bf16 v[20:23], v[64:67], v[96:99], 0
    ds_read_b64_tr_b16 v[70:71], v222 offset:16384
    s_add_u32 m0, s31, 49152
    v_mfma_f32_16x16x32_bf16 v[24:27], v[64:67], v[100:103], 0
    ds_read_b64_tr_b16 v[72:73], v225 offset:8192
    buffer_load_dwordx4 v210, s[16:19], s52 offen offset:0 lds
    v_mfma_f32_16x16x32_bf16 v[28:31], v[64:67], v[104:107], 0
    ds_read_b64_tr_b16 v[74:75], v225 offset:16384
    ds_read_b64_tr_b16 v[76:77], v246 offset:8192
    ds_read_b64_tr_b16 v[78:79], v246 offset:16384
    ds_read_b64_tr_b16 v[48:49], v203 offset:24576
    ds_read_b64_tr_b16 v[50:51], v203 offset:26624
    ds_read_b64_tr_b16 v[52:53], v203 offset:28672
    ds_read_b64_tr_b16 v[54:55], v203 offset:30720
    s_lshl_b32 s37, s67, 9
    s_waitcnt lgkmcnt(8)
    v_mfma_f32_16x16x32_bf16 v[16:19], v[68:71], a[0:3], v[16:19]
    ds_read_b64_tr_b16 v[56:57], v215 offset:32768
    v_mfma_f32_16x16x32_bf16 v[20:23], v[68:71], a[4:7], v[20:23]
    ds_read_b64_tr_b16 v[58:59], v215 offset:40960
    buffer_load_dwordx4 v211, s[16:19], s52 offen offset:1024 lds
    v_mfma_f32_16x16x32_bf16 v[24:27], v[68:71], a[8:11], v[24:27]
    v_cvt_pk_bf16_f32 v84, v32, v33
    v_mfma_f32_16x16x32_bf16 v[28:31], v[68:71], a[12:15], v[28:31]
    s_waitcnt lgkmcnt(8)
    v_mfma_f32_16x16x32_bf16 v[16:19], v[72:75], a[16:19], v[16:19]
    ds_read_b64_tr_b16 v[60:61], v222 offset:32768
    s_add_u32 m0, s31, 57344
    v_mfma_f32_16x16x32_bf16 v[20:23], v[72:75], a[20:23], v[20:23]
    ds_read_b64_tr_b16 v[62:63], v222 offset:40960
    v_cvt_pk_bf16_f32 v85, v34, v35
    v_mfma_f32_16x16x32_bf16 v[24:27], v[72:75], a[24:27], v[24:27]
    buffer_load_dwordx4 v210, s[16:19], s53 offen offset:0 lds
    v_mfma_f32_16x16x32_bf16 v[28:31], v[72:75], a[28:31], v[28:31]
    v_cvt_pk_bf16_f32 v86, v36, v37
    s_waitcnt lgkmcnt(8)
    v_mfma_f32_16x16x32_bf16 v[16:19], v[76:79], a[32:35], v[16:19]
    ds_read_b64_tr_b16 v[64:65], v225 offset:32768
    v_mfma_f32_16x16x32_bf16 v[20:23], v[76:79], a[36:39], v[20:23]
    ds_read_b64_tr_b16 v[66:67], v225 offset:40960
    buffer_load_dwordx4 v211, s[16:19], s53 offen offset:1024 lds
    v_mfma_f32_16x16x32_bf16 v[24:27], v[76:79], a[40:43], v[24:27]
    v_cvt_pk_bf16_f32 v87, v38, v39
    buffer_store_dwordx4 v[84:87], v221, s[20:23], s37 offen offset:0 sc1
    v_mfma_f32_16x16x32_bf16 v[28:31], v[76:79], a[44:47], v[28:31]
    s_waitcnt lgkmcnt(8)
    v_mfma_f32_16x16x32_bf16 v[16:19], v[48:51], a[48:51], v[16:19]
    ds_read_b64_tr_b16 v[68:69], v246 offset:32768
    s_add_u32 m0, s31, 65536
    v_mfma_f32_16x16x32_bf16 v[20:23], v[48:51], a[52:55], v[20:23]
    ds_read_b64_tr_b16 v[70:71], v246 offset:40960
    buffer_load_dwordx4 v210, s[16:19], s54 offen offset:0 lds
    v_mfma_f32_16x16x32_bf16 v[24:27], v[48:51], a[56:59], v[24:27]
    v_mfma_f32_16x16x32_bf16 v[28:31], v[48:51], a[60:63], v[28:31]
    s_waitcnt lgkmcnt(8)
    v_mfma_f32_16x16x32_bf16 v[16:19], v[52:55], a[64:67], v[16:19]
    ds_read_b64_tr_b16 v[72:73], v203 offset:49152
    v_mfma_f32_16x16x32_bf16 v[20:23], v[52:55], a[68:71], v[20:23]
    ds_read_b64_tr_b16 v[74:75], v203 offset:51200
    buffer_load_dwordx4 v211, s[16:19], s54 offen offset:1024 lds
    v_mfma_f32_16x16x32_bf16 v[24:27], v[52:55], a[72:75], v[24:27]
    v_mfma_f32_16x16x32_bf16 v[28:31], v[52:55], a[76:79], v[28:31]
    s_waitcnt vmcnt(14)
    s_barrier
    s_waitcnt lgkmcnt(8)
    v_mfma_f32_16x16x32_bf16 v[16:19], v[56:59], v[116:119], v[16:19]
    ds_read_b64_tr_b16 v[76:77], v203 offset:53248
    v_mfma_f32_16x16x32_bf16 v[20:23], v[56:59], v[120:123], v[20:23]
    ds_read_b64_tr_b16 v[78:79], v203 offset:55296
    s_add_u32 m0, s31, 122880
    v_mfma_f32_16x16x32_bf16 v[24:27], v[56:59], v[124:127], v[24:27]
    buffer_load_dwordx4 v210, s[16:19], s55 offen offset:0 lds
    v_mfma_f32_16x16x32_bf16 v[28:31], v[56:59], v[128:131], v[28:31]
    s_waitcnt lgkmcnt(8)
    v_mfma_f32_16x16x32_bf16 v[16:19], v[60:63], a[80:83], v[16:19]
    ds_read_b64_tr_b16 v[48:49], v214 offset:0
    v_mfma_f32_16x16x32_bf16 v[20:23], v[60:63], a[84:87], v[20:23]
    ds_read_b64_tr_b16 v[50:51], v214 offset:8192
    buffer_load_dwordx4 v211, s[16:19], s55 offen offset:1024 lds
    v_mfma_f32_16x16x32_bf16 v[24:27], v[60:63], a[88:91], v[24:27]
    v_cvt_pk_bf16_f32 v88, v40, v41
    v_mfma_f32_16x16x32_bf16 v[28:31], v[60:63], a[92:95], v[28:31]
    s_waitcnt lgkmcnt(8)
    v_mfma_f32_16x16x32_bf16 v[16:19], v[64:67], a[96:99], v[16:19]
    ds_read_b64_tr_b16 v[52:53], v217 offset:0
    s_add_u32 m0, s31, 131072
    v_mfma_f32_16x16x32_bf16 v[20:23], v[64:67], a[100:103], v[20:23]
    ds_read_b64_tr_b16 v[54:55], v217 offset:8192
    v_cvt_pk_bf16_f32 v89, v42, v43
    v_mfma_f32_16x16x32_bf16 v[24:27], v[64:67], a[104:107], v[24:27]
    buffer_load_dwordx4 v210, s[16:19], s56 offen offset:0 lds
    v_mfma_f32_16x16x32_bf16 v[28:31], v[64:67], a[108:111], v[28:31]
    v_cvt_pk_bf16_f32 v90, v44, v45
    s_waitcnt lgkmcnt(8)
    v_mfma_f32_16x16x32_bf16 v[16:19], v[68:71], a[112:115], v[16:19]
    ds_read_b64_tr_b16 v[56:57], v224 offset:0
    v_mfma_f32_16x16x32_bf16 v[20:23], v[68:71], a[116:119], v[20:23]
    ds_read_b64_tr_b16 v[58:59], v224 offset:8192
    buffer_load_dwordx4 v211, s[16:19], s56 offen offset:1024 lds
    v_mfma_f32_16x16x32_bf16 v[24:27], v[68:71], a[120:123], v[24:27]
    v_cvt_pk_bf16_f32 v91, v46, v47
    buffer_store_dwordx4 v[88:91], v221, s[20:23], s37 offen offset:1024 sc1
    v_mfma_f32_16x16x32_bf16 v[28:31], v[68:71], a[124:127], v[28:31]
    s_waitcnt lgkmcnt(8)
    v_mfma_f32_16x16x32_bf16 v[16:19], v[72:75], a[128:131], v[16:19]
    ds_read_b64_tr_b16 v[60:61], v227 offset:0
    s_add_u32 m0, s31, 139264
    v_mfma_f32_16x16x32_bf16 v[20:23], v[72:75], a[132:135], v[20:23]
    ds_read_b64_tr_b16 v[62:63], v227 offset:8192
    buffer_load_dwordx4 v210, s[16:19], s57 offen offset:0 lds
    v_mfma_f32_16x16x32_bf16 v[24:27], v[72:75], a[136:139], v[24:27]
    v_mfma_f32_16x16x32_bf16 v[28:31], v[72:75], a[140:143], v[28:31]
    s_waitcnt lgkmcnt(8)
    v_mfma_f32_16x16x32_bf16 v[16:19], v[76:79], a[144:147], v[16:19]
    ds_read_b64_tr_b16 v[64:65], v202 offset:16384
    v_mfma_f32_16x16x32_bf16 v[20:23], v[76:79], a[148:151], v[20:23]
    ds_read_b64_tr_b16 v[66:67], v202 offset:18432
    buffer_load_dwordx4 v211, s[16:19], s57 offen offset:1024 lds
    v_mfma_f32_16x16x32_bf16 v[24:27], v[76:79], a[152:155], v[24:27]
    v_mfma_f32_16x16x32_bf16 v[28:31], v[76:79], a[156:159], v[28:31]
    s_waitcnt vmcnt(14)
    v_readfirstlane_b32 s36, v244
    s_nop 3
    s_cmp_lg_u32 s36, 0
    s_cbranch_scc1 L_tag1_ok
    s_mov_b32 s62, 200000
L_tag1_loop:
    buffer_load_dword v244, v243, s[4:7], 0 offen sc1
    s_waitcnt vmcnt(0)
    v_readfirstlane_b32 s36, v244
    s_nop 3
    s_cmp_lg_u32 s36, 0
    s_cbranch_scc1 L_tag1_ok
    s_sub_u32 s62, s62, 1
    s_cmp_lg_u32 s62, 0
    s_cbranch_scc1 L_tag1_loop
L_tag1_ok:
    s_mov_b64 vcc, 0
    s_barrier
    s_waitcnt lgkmcnt(8)
    v_mfma_f32_16x16x32_bf16 v[16:19], v[48:51], v[140:143], v[16:19]
    ds_read_b64_tr_b16 v[68:69], v202 offset:20480
    v_add_u32 v210, s70, v212
    v_mfma_f32_16x16x32_bf16 v[20:23], v[48:51], v[144:147], v[20:23]
    ds_read_b64_tr_b16 v[70:71], v202 offset:22528
    v_add_u32 v211, s70, v213
    v_mfma_f32_16x16x32_bf16 v[24:27], v[48:51], v[148:151], v[24:27]
    s_add_u32 m0, s31, 73728
    s_nop 0
    buffer_load_dwordx4 v210, s[16:19], s49 offen offset:0 lds
    v_mfma_f32_16x16x32_bf16 v[28:31], v[48:51], v[152:155], v[28:31]
    s_waitcnt lgkmcnt(8)
    v_mfma_f32_16x16x32_bf16 v[16:19], v[52:55], a[160:163], v[16:19]
    ds_read_b64_tr_b16 v[72:73], v214 offset:24576
    v_mfma_f32_16x16x32_bf16 v[20:23], v[52:55], a[164:167], v[20:23]
    ds_read_b64_tr_b16 v[74:75], v214 offset:32768
    buffer_load_dwordx4 v211, s[16:19], s49 offen offset:1024 lds
    v_mfma_f32_16x16x32_bf16 v[24:27], v[52:55], a[168:171], v[24:27]
    v_mfma_f32_16x16x32_bf16 v[28:31], v[52:55], a[172:175], v[28:31]
    s_waitcnt lgkmcnt(8)
    v_mfma_f32_16x16x32_bf16 v[16:19], v[56:59], a[176:179], v[16:19]
    ds_read_b64_tr_b16 v[76:77], v217 offset:24576
    s_add_u32 m0, s31, 81920
    v_mfma_f32_16x16x32_bf16 v[20:23], v[56:59], a[180:183], v[20:23]
    ds_read_b64_tr_b16 v[78:79], v217 offset:32768
    buffer_load_dwordx4 v210, s[16:19], s50 offen offset:0 lds
    v_mfma_f32_16x16x32_bf16 v[24:27], v[56:59], a[184:187], v[24:27]
    v_mfma_f32_16x16x32_bf16 v[28:31], v[56:59], a[188:191], v[28:31]
    s_waitcnt lgkmcnt(8)
    v_mfma_f32_16x16x32_bf16 v[16:19], v[60:63], a[192:195], v[16:19]
    ds_read_b64_tr_b16 v[48:49], v224 offset:24576
    v_mfma_f32_16x16x32_bf16 v[20:23], v[60:63], a[196:199], v[20:23]
    ds_read_b64_tr_b16 v[50:51], v224 offset:32768
L_pg12:
    s_cbranch_vccnz L_pg16
    buffer_load_dwordx4 v211, s[16:19], s50 offen offset:1024 lds
    v_mfma_f32_16x16x32_bf16 v[24:27], v[60:63], a[200:203], v[24:27]
    v_mfma_f32_16x16x32_bf16 v[28:31], v[60:63], a[204:207], v[28:31]
    s_waitcnt lgkmcnt(8)
    v_mfma_f32_16x16x32_bf16 v[16:19], v[64:67], a[208:211], v[16:19]
    ds_read_b64_tr_b16 v[52:53], v227 offset:24576
    s_add_u32 m0, s31, 90112
    v_mfma_f32_16x16x32_bf16 v[20:23], v[64:67], a[212:215], v[20:23]
L_pg13:
    s_cbranch_vccnz L_pg17
    ds_read_b64_tr_b16 v[54:55], v227 offset:32768
    buffer_load_dwordx4 v210, s[16:19], s51 offen offset:0 lds
    v_mfma_f32_16x16x32_bf16 v[24:27], v[64:67], a[216:219], v[24:27]
    v_mfma_f32_16x16x32_bf16 v[28:31], v[64:67], a[220:223], v[28:31]
    s_waitcnt lgkmcnt(8)
    v_mfma_f32_16x16x32_bf16 v[16:19], v[68:71], a[224:227], v[16:19]
    ds_read_b64_tr_b16 v[56:57], v202 offset:40960
    v_mfma_f32_16x16x32_bf16 v[20:23], v[68:71], a[228:231], v[20:23]
L_pg14:
    s_cbranch_vccnz L_pg18
    ds_read_b64_tr_b16 v[58:59], v202 offset:43008
    buffer_load_dwordx4 v211, s[16:19], s51 offen offset:1024 lds
    v_mfma_f32_16x16x32_bf16 v[24:27], v[68:71], a[232:235], v[24:27]
    v_mfma_f32_16x16x32_bf16 v[28:31], v[68:71], a[236:239], v[28:31]
    s_waitcnt vmcnt(13)
    s_barrier
    s_waitcnt lgkmcnt(8)
    v_mfma_f32_16x16x32_bf16 v[32:35], v[72:75], v[92:95], 0
    ds_read_b64_tr_b16 v[60:61], v202 offset:45056
    v_mfma_f32_16x16x32_bf16 v[36:39], v[72:75], v[96:99], 0
    ds_read_b64_tr_b16 v[62:63], v202 offset:47104
    s_add_u32 m0, s31, 98304
    v_mfma_f32_16x16x32_bf16 v[40:43], v[72:75], v[100:103], 0
    buffer_load_dwordx4 v210, s[16:19], s52 offen offset:0 lds
    v_mfma_f32_16x16x32_bf16 v[44:47], v[72:75], v[104:107], 0
    s_lshl_b32 s37, s68, 9
    s_waitcnt lgkmcnt(8)
    v_mfma_f32_16x16x32_bf16 v[32:35], v[76:79], a[0:3], v[32:35]
    ds_read_b64_tr_b16 v[64:65], v214 offset:49152
    v_mfma_f32_16x16x32_bf16 v[36:39], v[76:79], a[4:7], v[36:39]
    ds_read_b64_tr_b16 v[66:67], v214 offset:57344
    buffer_load_dwordx4 v211, s[16:19], s52 offen offset:1024 lds
    v_mfma_f32_16x16x32_bf16 v[40:43], v[76:79], a[8:11], v[40:43]
    v_cvt_pk_bf16_f32 v84, v16, v17
    v_mfma_f32_16x16x32_bf16 v[44:47], v[76:79], a[12:15], v[44:47]
    s_waitcnt lgkmcnt(8)
    v_mfma_f32_16x16x32_bf16 v[32:35], v[48:51], a[16:19], v[32:35]
    ds_read_b64_tr_b16 v[68:69], v217 offset:49152
    s_add_u32 m0, s31, 106496
    v_mfma_f32_16x16x32_bf16 v[36:39], v[48:51], a[20:23], v[36:39]
    ds_read_b64_tr_b16 v[70:71], v217 offset:57344
    v_cvt_pk_bf16_f32 v85, v18, v19
    v_mfma_f32_16x16x32_bf16 v[40:43], v[48:51], a[24:27], v[40:43]
    buffer_load_dwordx4 v210, s[16:19], s53 offen offset:0 lds
    v_mfma_f32_16x16x32_bf16 v[44:47], v[48:51], a[28:31], v[44:47]
    v_cvt_pk_bf16_f32 v86, v20, v21
    s_waitcnt lgkmcnt(8)
    v_mfma_f32_16x16x32_bf16 v[32:35], v[52:55], a[32:35], v[32:35]
    ds_read_b64_tr_b16 v[72:73], v224 offset:49152
    v_mfma_f32_16x16x32_bf16 v[36:39], v[52:55], a[36:39], v[36:39]
    ds_read_b64_tr_b16 v[74:75], v224 offset:57344
    buffer_load_dwordx4 v211, s[16:19], s53 offen offset:1024 lds
    v_mfma_f32_16x16x32_bf16 v[40:43], v[52:55], a[40:43], v[40:43]
    v_cvt_pk_bf16_f32 v87, v22, v23
    buffer_store_dwordx4 v[84:87], v221, s[20:23], s37 offen offset:0 sc1
    v_mfma_f32_16x16x32_bf16 v[44:47], v[52:55], a[44:47], v[44:47]
    s_waitcnt lgkmcnt(8)
    v_mfma_f32_16x16x32_bf16 v[32:35], v[56:59], a[48:51], v[32:35]
    ds_read_b64_tr_b16 v[76:77], v227 offset:49152
    s_add_u32 m0, s31, 114688
    v_mfma_f32_16x16x32_bf16 v[36:39], v[56:59], a[52:55], v[36:39]
    ds_read_b64_tr_b16 v[78:79], v227 offset:57344
    buffer_load_dwordx4 v210, s[16:19], s54 offen offset:0 lds
    v_mfma_f32_16x16x32_bf16 v[40:43], v[56:59], a[56:59], v[40:43]
    v_mfma_f32_16x16x32_bf16 v[44:47], v[56:59], a[60:63], v[44:47]
    s_waitcnt lgkmcnt(8)
    v_mfma_f32_16x16x32_bf16 v[32:35], v[60:63], a[64:67], v[32:35]
    ds_read_b64_tr_b16 v[48:49], v203 offset:0
    v_mfma_f32_16x16x32_bf16 v[36:39], v[60:63], a[68:71], v[36:39]
    ds_read_b64_tr_b16 v[50:51], v203 offset:2048
    buffer_load_dwordx4 v211, s[16:19], s54 offen offset:1024 lds
    v_mfma_f32_16x16x32_bf16 v[40:43], v[60:63], a[72:75], v[40:43]
    v_mfma_f32_16x16x32_bf16 v[44:47], v[60:63], a[76:79], v[44:47]
    s_waitcnt vmcnt(13)
    s_barrier
    s_waitcnt lgkmcnt(8)
    v_mfma_f32_16x16x32_bf16 v[32:35], v[64:67], v[116:119], v[32:35]
    ds_read_b64_tr_b16 v[52:53], v203 offset:4096
    v_mfma_f32_16x16x32_bf16 v[36:39], v[64:67], v[120:123], v[36:39]
    ds_read_b64_tr_b16 v[54:55], v203 offset:6144
    s_add_u32 m0, s31, 0
    v_mfma_f32_16x16x32_bf16 v[40:43], v[64:67], v[124:127], v[40:43]
    buffer_load_dwordx4 v210, s[16:19], s55 offen offset:0 lds
    v_mfma_f32_16x16x32_bf16 v[44:47], v[64:67], v[128:131], v[44:47]
    s_waitcnt lgkmcnt(8)
    v_mfma_f32_16x16x32_bf16 v[32:35], v[68:71], a[80:83], v[32:35]
    ds_read_b64_tr_b16 v[56:57], v215 offset:57344
    v_mfma_f32_16x16x32_bf16 v[36:39], v[68:71], a[84:87], v[36:39]
    ds_read_b64_tr_b16 v[58:59], v216 offset:0
    buffer_load_dwordx4 v211, s[16:19], s55 offen offset:1024 lds
    v_mfma_f32_16x16x32_bf16 v[40:43], v[68:71], a[88:91], v[40:43]
    v_cvt_pk_bf16_f32 v88, v24, v25
    v_mfma_f32_16x16x32_bf16 v[44:47], v[68:71], a[92:95], v[44:47]
    s_waitcnt lgkmcnt(8)
    v_mfma_f32_16x16x32_bf16 v[32:35], v[72:75], a[96:99], v[32:35]
    ds_read_b64_tr_b16 v[60:61], v222 offset:57344
    s_add_u32 m0, s31, 8192
    v_mfma_f32_16x16x32_bf16 v[36:39], v[72:75], a[100:103], v[36:39]
    ds_read_b64_tr_b16 v[62:63], v223 offset:0
    v_cvt_pk_bf16_f32 v89, v26, v27
    v_mfma_f32_16x16x32_bf16 v[40:43], v[72:75], a[104:107], v[40:43]
    buffer_load_dwordx4 v210, s[16:19], s56 offen offset:0 lds
    v_mfma_f32_16x16x32_bf16 v[44:47], v[72:75], a[108:111], v[44:47]
    v_cvt_pk_bf16_f32 v90, v28, v29
    s_waitcnt lgkmcnt(8)
    v_mfma_f32_16x16x32_bf16 v[32:35], v[76:79], a[112:115], v[32:35]
    ds_read_b64_tr_b16 v[64:65], v225 offset:57344
    v_mfma_f32_16x16x32_bf16 v[36:39], v[76:79], a[116:119], v[36:39]
    ds_read_b64_tr_b16 v[66:67], v226 offset:0
    buffer_load_dwordx4 v211, s[16:19], s56 offen offset:1024 lds
    v_mfma_f32_16x16x32_bf16 v[40:43], v[76:79], a[120:123], v[40:43]
    v_cvt_pk_bf16_f32 v91, v30, v31
    buffer_store_dwordx4 v[88:91], v221, s[20:23], s37 offen offset:1024 sc1
    v_mfma_f32_16x16x32_bf16 v[44:47], v[76:79], a[124:127], v[44:47]
    s_waitcnt lgkmcnt(8)
    v_mfma_f32_16x16x32_bf16 v[32:35], v[48:51], a[128:131], v[32:35]
    ds_read_b64_tr_b16 v[68:69], v246 offset:57344
    s_add_u32 m0, s31, 16384
    v_mfma_f32_16x16x32_bf16 v[36:39], v[48:51], a[132:135], v[36:39]
    ds_read_b64_tr_b16 v[70:71], v247 offset:0
    buffer_load_dwordx4 v210, s[16:19], s57 offen offset:0 lds
    v_mfma_f32_16x16x32_bf16 v[40:43], v[48:51], a[136:139], v[40:43]
    v_mfma_f32_16x16x32_bf16 v[44:47], v[48:51], a[140:143], v[44:47]
    s_waitcnt lgkmcnt(8)
    v_mfma_f32_16x16x32_bf16 v[32:35], v[52:55], a[144:147], v[32:35]
    ds_read_b64_tr_b16 v[72:73], v204 offset:8192
    v_mfma_f32_16x16x32_bf16 v[36:39], v[52:55], a[148:151], v[36:39]
    ds_read_b64_tr_b16 v[74:75], v204 offset:10240
    buffer_load_dwordx4 v211, s[16:19], s57 offen offset:1024 lds
    v_mfma_f32_16x16x32_bf16 v[40:43], v[52:55], a[152:155], v[40:43]
    v_mfma_f32_16x16x32_bf16 v[44:47], v[52:55], a[156:159], v[44:47]
    s_waitcnt vmcnt(14)
    s_barrier
    s_waitcnt lgkmcnt(8)
    v_mfma_f32_16x16x32_bf16 v[32:35], v[56:59], v[140:143], v[32:35]
    ds_read_b64_tr_b16 v[76:77], v204 offset:12288
    v_add_u32 v210, s71, v212
    v_mfma_f32_16x16x32_bf16 v[36:39], v[56:59], v[144:147], v[36:39]
    ds_read_b64_tr_b16 v[78:79], v204 offset:14336
    v_add_u32 v211, s71, v213
    v_mfma_f32_16x16x32_bf16 v[40:43], v[56:59], v[148:151], v[40:43]
    s_add_u32 m0, s31, 24576
    s_sub_u32 s40, s29, 1
    v_mfma_f32_16x16x32_bf16 v[44:47], v[56:59], v[152:155], v[44:47]
    buffer_load_dwordx4 v210, s[16:19], s49 offen offset:0 lds
    s_and_b32 s40, s40, 7
    s_waitcnt lgkmcnt(8)
    v_mfma_f32_16x16x32_bf16 v[32:35], v[60:63], a[160:163], v[32:35]
    ds_read_b64_tr_b16 v[48:49], v215 offset:8192
    s_lshl_b32 s40, s40, 13
    v_mfma_f32_16x16x32_bf16 v[36:39], v[60:63], a[164:167], v[36:39]
    ds_read_b64_tr_b16 v[50:51], v215 offset:16384
    s_sub_u32 s41, s29, 2
    v_mfma_f32_16x16x32_bf16 v[40:43], v[60:63], a[168:171], v[40:43]
    buffer_load_dwordx4 v211, s[16:19], s49 offen offset:1024 lds
    s_and_b32 s41, s41, 7
    v_mfma_f32_16x16x32_bf16 v[44:47], v[60:63], a[172:175], v[44:47]
    s_lshl_b32 s41, s41, 13
    s_sub_u32 s42, s29, 3
    s_waitcnt lgkmcnt(8)
    v_mfma_f32_16x16x32_bf16 v[32:35], v[64:67], a[176:179], v[32:35]
    ds_read_b64_tr_b16 v[52:53], v222 offset:8192
    s_add_u32 m0, s31, 32768
    v_mfma_f32_16x16x32_bf16 v[36:39], v[64:67], a[180:183], v[36:39]
    ds_read_b64_tr_b16 v[54:55], v222 offset:16384
    s_and_b32 s42, s42, 7
    v_mfma_f32_16x16x32_bf16 v[40:43], v[64:67], a[184:187], v[40:43]
    buffer_load_dwordx4 v210, s[16:19], s50 offen offset:0 lds
    s_lshl_b32 s42, s42, 13
    v_mfma_f32_16x16x32_bf16 v[44:47], v[64:67], a[188:191], v[44:47]
    s_sub_u32 s43, s29, 4
    s_waitcnt lgkmcnt(8)
    v_mfma_f32_16x16x32_bf16 v[32:35], v[68:71], a[192:195], v[32:35]
    ds_read_b64_tr_b16 v[56:57], v225 offset:8192
    s_and_b32 s43, s43, 7
    v_mfma_f32_16x16x32_bf16 v[36:39], v[68:71], a[196:199], v[36:39]
    ds_read_b64_tr_b16 v[58:59], v225 offset:16384
    s_lshl_b32 s43, s43, 13
    v_mfma_f32_16x16x32_bf16 v[40:43], v[68:71], a[200:203], v[40:43]
    buffer_load_dwordx4 v211, s[16:19], s50 offen offset:1024 lds
    s_sub_u32 s44, s29, 5
    v_mfma_f32_16x16x32_bf16 v[44:47], v[68:71], a[204:207], v[44:47]
    s_and_b32 s44, s44, 7
    s_waitcnt lgkmcnt(8)
    v_mfma_f32_16x16x32_bf16 v[32:35], v[72:75], a[208:211], v[32:35]
    ds_read_b64_tr_b16 v[60:61], v246 offset:8192
    s_lshl_b32 s44, s44, 13
    v_mfma_f32_16x16x32_bf16 v[36:39], v[72:75], a[212:215], v[36:39]
    ds_read_b64_tr_b16 v[62:63], v246 offset:16384
    s_add_u32 m0, s31, 40960
    v_mfma_f32_16x16x32_bf16 v[40:43], v[72:75], a[216:219], v[40:43]
    s_sub_u32 s45, s29, 6
    buffer_load_dwordx4 v210, s[16:19], s51 offen offset:0 lds
    v_mfma_f32_16x16x32_bf16 v[44:47], v[72:75], a[220:223], v[44:47]
    s_and_b32 s45, s45, 7
    s_waitcnt lgkmcnt(8)
    v_mfma_f32_16x16x32_bf16 v[32:35], v[76:79], a[224:227], v[32:35]
    ds_read_b64_tr_b16 v[64:65], v203 offset:24576
    s_lshl_b32 s45, s45, 13
    v_mfma_f32_16x16x32_bf16 v[36:39], v[76:79], a[228:231], v[36:39]
    ds_read_b64_tr_b16 v[66:67], v203 offset:26624
    s_sub_u32 s46, s29, 7
    v_mfma_f32_16x16x32_bf16 v[40:43], v[76:79], a[232:235], v[40:43]
    s_and_b32 s46, s46, 7
    buffer_load_dwordx4 v211, s[16:19], s51 offen offset:1024 lds
    v_mfma_f32_16x16x32_bf16 v[44:47], v[76:79], a[236:239], v[44:47]
    s_lshl_b32 s46, s46, 13
    s_waitcnt vmcnt(13)
    s_barrier
    s_waitcnt lgkmcnt(8)
    v_mfma_f32_16x16x32_bf16 v[16:19], v[48:51], v[92:95], 0
    ds_read_b64_tr_b16 v[68:69], v203 offset:28672
    v_mfma_f32_16x16x32_bf16 v[20:23], v[48:51], v[96:99], 0
    ds_read_b64_tr_b16 v[70:71], v203 offset:30720
    s_add_u32 m0, s31, 49152
    v_mfma_f32_16x16x32_bf16 v[24:27], v[48:51], v[100:103], 0
    buffer_load_dwordx4 v210, s[16:19], s52 offen offset:0 lds
    v_mfma_f32_16x16x32_bf16 v[28:31], v[48:51], v[104:107], 0
    s_lshl_b32 s37, s69, 9
    s_waitcnt lgkmcnt(8)
    v_mfma_f32_16x16x32_bf16 v[16:19], v[52:55], a[0:3], v[16:19]
    ds_read_b64_tr_b16 v[72:73], v215 offset:32768
    v_mfma_f32_16x16x32_bf16 v[20:23], v[52:55], a[4:7], v[20:23]
    ds_read_b64_tr_b16 v[74:75], v215 offset:40960
    buffer_load_dwordx4 v211, s[16:19], s52 offen offset:1024 lds
    v_mfma_f32_16x16x32_bf16 v[24:27], v[52:55], a[8:11], v[24:27]
    v_cvt_pk_bf16_f32 v84, v32, v33
    v_mfma_f32_16x16x32_bf16 v[28:31], v[52:55], a[12:15], v[28:31]
    s_waitcnt lgkmcnt(8)
    v_mfma_f32_16x16x32_bf16 v[16:19], v[56:59], a[16:19], v[16:19]
    ds_read_b64_tr_b16 v[76:77], v222 offset:32768
    s_add_u32 m0, s31, 57344
    v_mfma_f32_16x16x32_bf16 v[20:23], v[56:59], a[20:23], v[20:23]
    ds_read_b64_tr_b16 v[78:79], v222 offset:40960
    v_cvt_pk_bf16_f32 v85, v34, v35
    v_mfma_f32_16x16x32_bf16 v[24:27], v[56:59], a[24:27], v[24:27]
    buffer_load_dwordx4 v210, s[16:19], s53 offen offset:0 lds
    v_mfma_f32_16x16x32_bf16 v[28:31], v[56:59], a[28:31], v[28:31]
    v_cvt_pk_bf16_f32 v86, v36, v37
    s_waitcnt lgkmcnt(8)
    v_mfma_f32_16x16x32_bf16 v[16:19], v[60:63], a[32:35], v[16:19]
    ds_read_b64_tr_b16 v[48:49], v225 offset:32768
    v_mfma_f32_16x16x32_bf16 v[20:23], v[60:63], a[36:39], v[20:23]
    ds_read_b64_tr_b16 v[50:51], v225 offset:40960
    buffer_load_dwordx4 v211, s[16:19], s53 offen offset:1024 lds
    v_mfma_f32_16x16x32_bf16 v[24:27], v[60:63], a[40:43], v[24:27]
    v_cvt_pk_bf16_f32 v87, v38, v39
    buffer_store_dwordx4 v[84:87], v221, s[20:23], s37 offen offset:0 sc1
    v_mfma_f32_16x16x32_bf16 v[28:31], v[60:63], a[44:47], v[28:31]
    s_waitcnt lgkmcnt(8)
    v_mfma_f32_16x16x32_bf16 v[16:19], v[64:67], a[48:51], v[16:19]
    ds_read_b64_tr_b16 v[52:53], v246 offset:32768
    s_add_u32 m0, s31, 65536
    v_mfma_f32_16x16x32_bf16 v[20:23], v[64:67], a[52:55], v[20:23]
    ds_read_b64_tr_b16 v[54:55], v246 offset:40960
    buffer_load_dwordx4 v210, s[16:19], s54 offen offset:0 lds
    v_mfma_f32_16x16x32_bf16 v[24:27], v[64:67], a[56:59], v[24:27]
    v_mfma_f32_16x16x32_bf16 v[28:31], v[64:67], a[60:63], v[28:31]
    s_waitcnt lgkmcnt(8)
    v_mfma_f32_16x16x32_bf16 v[16:19], v[68:71], a[64:67], v[16:19]
    ds_read_b64_tr_b16 v[56:57], v203 offset:49152
    v_mfma_f32_16x16x32_bf16 v[20:23], v[68:71], a[68:71], v[20:23]
    ds_read_b64_tr_b16 v[58:59], v203 offset:51200
    buffer_load_dwordx4 v211, s[16:19], s54 offen offset:1024 lds
    v_mfma_f32_16x16x32_bf16 v[24:27], v[68:71], a[72:75], v[24:27]
    v_mfma_f32_16x16x32_bf16 v[28:31], v[68:71], a[76:79], v[28:31]
    s_waitcnt vmcnt(13)
    s_barrier
    s_waitcnt lgkmcnt(8)
    v_mfma_f32_16x16x32_bf16 v[16:19], v[72:75], v[116:119], v[16:19]
    ds_read_b64_tr_b16 v[60:61], v203 offset:53248
    v_mfma_f32_16x16x32_bf16 v[20:23], v[72:75], v[120:123], v[20:23]
    ds_read_b64_tr_b16 v[62:63], v203 offset:55296
    s_add_u32 m0, s31, 122880
    v_mfma_f32_16x16x32_bf16 v[24:27], v[72:75], v[124:127], v[24:27]
    buffer_load_dwordx4 v210, s[16:19], s55 offen offset:0 lds
    v_mfma_f32_16x16x32_bf16 v[28:31], v[72:75], v[128:131], v[28:31]
    s_waitcnt lgkmcnt(8)
    v_mfma_f32_16x16x32_bf16 v[16:19], v[76:79], a[80:83], v[16:19]
    ds_read_b64_tr_b16 v[64:65], v214 offset:0
    v_mfma_f32_16x16x32_bf16 v[20:23], v[76:79], a[84:87], v[20:23]
    ds_read_b64_tr_b16 v[66:67], v214 offset:8192
    buffer_load_dwordx4 v211, s[16:19], s55 offen offset:1024 lds
    v_mfma_f32_16x16x32_bf16 v[24:27], v[76:79], a[88:91], v[24:27]
    v_cvt_pk_bf16_f32 v88, v40, v41
    v_mfma_f32_16x16x32_bf16 v[28:31], v[76:79], a[92:95], v[28:31]
    s_waitcnt lgkmcnt(8)
    v_mfma_f32_16x16x32_bf16 v[16:19], v[48:51], a[96:99], v[16:19]
    ds_read_b64_tr_b16 v[68:69], v217 offset:0
    s_add_u32 m0, s31, 131072
    v_mfma_f32_16x16x32_bf16 v[20:23], v[48:51], a[100:103], v[20:23]
    ds_read_b64_tr_b16 v[70:71], v217 offset:8192
    v_cvt_pk_bf16_f32 v89, v42, v43
    v_mfma_f32_16x16x32_bf16 v[24:27], v[48:51], a[104:107], v[24:27]
    buffer_load_dwordx4 v210, s[16:19], s56 offen offset:0 lds
    v_mfma_f32_16x16x32_bf16 v[28:31], v[48:51], a[108:111], v[28:31]
    v_cvt_pk_bf16_f32 v90, v44, v45
    s_waitcnt lgkmcnt(8)
    v_mfma_f32_16x16x32_bf16 v[16:19], v[52:55], a[112:115], v[16:19]
    ds_read_b64_tr_b16 v[72:73], v224 offset:0
    v_mfma_f32_16x16x32_bf16 v[20:23], v[52:55], a[116:119], v[20:23]
    ds_read_b64_tr_b16 v[74:75], v224 offset:8192
    buffer_load_dwordx4 v211, s[16:19], s56 offen offset:1024 lds
    v_mfma_f32_16x16x32_bf16 v[24:27], v[52:55], a[120:123], v[24:27]
    v_cvt_pk_bf16_f32 v91, v46, v47
    buffer_store_dwordx4 v[88:91], v221, s[20:23], s37 offen offset:1024 sc1
    v_mfma_f32_16x16x32_bf16 v[28:31], v[52:55], a[124:127], v[28:31]
    s_waitcnt lgkmcnt(8)
    v_mfma_f32_16x16x32_bf16 v[16:19], v[56:59], a[128:131], v[16:19]
    ds_read_b64_tr_b16 v[76:77], v227 offset:0
    s_add_u32 m0, s31, 139264
    v_mfma_f32_16x16x32_bf16 v[20:23], v[56:59], a[132:135], v[20:23]
    ds_read_b64_tr_b16 v[78:79], v227 offset:8192
    buffer_load_dwordx4 v210, s[16:19], s57 offen offset:0 lds
    v_mfma_f32_16x16x32_bf16 v[24:27], v[56:59], a[136:139], v[24:27]
    v_mfma_f32_16x16x32_bf16 v[28:31], v[56:59], a[140:143], v[28:31]
    s_waitcnt lgkmcnt(8)
    v_mfma_f32_16x16x32_bf16 v[16:19], v[60:63], a[144:147], v[16:19]
    ds_read_b64_tr_b16 v[48:49], v202 offset:16384
    v_mfma_f32_16x16x32_bf16 v[20:23], v[60:63], a[148:151], v[20:23]
    ds_read_b64_tr_b16 v[50:51], v202 offset:18432
    buffer_load_dwordx4 v211, s[16:19], s57 offen offset:1024 lds
    v_mfma_f32_16x16x32_bf16 v[24:27], v[60:63], a[152:155], v[24:27]
    v_mfma_f32_16x16x32_bf16 v[28:31], v[60:63], a[156:159], v[28:31]
    s_waitcnt vmcnt(14)
    s_barrier
    s_waitcnt lgkmcnt(8)
    v_mfma_f32_16x16x32_bf16 v[16:19], v[64:67], v[140:143], v[16:19]
    ds_read_b64_tr_b16 v[52:53], v202 offset:20480
    v_add_u32 v210, s72, v212
    v_mfma_f32_16x16x32_bf16 v[20:23], v[64:67], v[144:147], v[20:23]
    ds_read_b64_tr_b16 v[54:55], v202 offset:22528
    v_add_u32 v211, s72, v213
    v_mfma_f32_16x16x32_bf16 v[24:27], v[64:67], v[148:151], v[24:27]
    s_mov_b32 s58, 0xff
    s_add_u32 m0, s31, 73728
    v_mfma_f32_16x16x32_bf16 v[28:31], v[64:67], v[152:155], v[28:31]
    s_bitset0_b32 s58, s29
    buffer_load_dwordx4 v210, s[16:19], s49 offen offset:0 lds
    s_waitcnt lgkmcnt(8)
    v_mfma_f32_16x16x32_bf16 v[16:19], v[68:71], a[160:163], v[16:19]
    ds_read_b64_tr_b16 v[56:57], v214 offset:24576
    s_mov_b32 s59, 0
    v_mfma_f32_16x16x32_bf16 v[20:23], v[68:71], a[164:167], v[20:23]
    ds_read_b64_tr_b16 v[58:59], v214 offset:32768
    s_mov_b32 s60, 0
    v_mfma_f32_16x16x32_bf16 v[24:27], v[68:71], a[168:171], v[24:27]
    s_lshr_b32 s62, s40, 13
    s_bitset1_b32 s60, s62
    v_mfma_f32_16x16x32_bf16 v[28:31], v[68:71], a[172:175], v[28:31]
    buffer_load_dwordx4 v211, s[16:19], s49 offen offset:1024 lds
    s_lshr_b32 s62, s41, 13
    s_waitcnt lgkmcnt(8)
    v_mfma_f32_16x16x32_bf16 v[16:19], v[72:75], a[176:179], v[16:19]
    ds_read_b64_tr_b16 v[60:61], v217 offset:24576
    s_bitset1_b32 s60, s62
    v_mfma_f32_16x16x32_bf16 v[20:23], v[72:75], a[180:183], v[20:23]
    ds_read_b64_tr_b16 v[62:63], v217 offset:32768
    s_lshr_b32 s62, s42, 13
    v_mfma_f32_16x16x32_bf16 v[24:27], v[72:75], a[184:187], v[24:27]
    s_add_u32 m0, s31, 81920
    s_bitset1_b32 s60, s62
    v_mfma_f32_16x16x32_bf16 v[28:31], v[72:75], a[188:191], v[28:31]
    buffer_load_dwordx4 v210, s[16:19], s50 offen offset:0 lds
    s_lshr_b32 s62, s45, 13
    s_waitcnt lgkmcnt(8)
    v_mfma_f32_16x16x32_bf16 v[16:19], v[76:79], a[192:195], v[16:19]
    ds_read_b64_tr_b16 v[64:65], v224 offset:24576
    s_bitset1_b32 s59, s62
    v_mfma_f32_16x16x32_bf16 v[20:23], v[76:79], a[196:199], v[20:23]
    ds_read_b64_tr_b16 v[66:67], v224 offset:32768
    s_lshr_b32 s62, s46, 13
    v_mfma_f32_16x16x32_bf16 v[24:27], v[76:79], a[200:203], v[24:27]
    s_bitset1_b32 s59, s62
    buffer_load_dwordx4 v211, s[16:19], s50 offen offset:1024 lds
    v_mfma_f32_16x16x32_bf16 v[28:31], v[76:79], a[204:207], v[28:31]
    s_lshl_b32 s62, s3, 16
    s_waitcnt lgkmcnt(8)
    v_mfma_f32_16x16x32_bf16 v[16:19], v[48:51], a[208:211], v[16:19]
    ds_read_b64_tr_b16 v[68:69], v227 offset:24576
    s_add_u32 s40, s40, s62
    v_mfma_f32_16x16x32_bf16 v[20:23], v[48:51], a[212:215], v[20:23]
    ds_read_b64_tr_b16 v[70:71], v227 offset:32768
    s_add_u32 s41, s41, s62
    v_mfma_f32_16x16x32_bf16 v[24:27], v[48:51], a[216:219], v[24:27]
    s_add_u32 m0, s31, 90112
    s_add_u32 s42, s42, s62
    v_mfma_f32_16x16x32_bf16 v[28:31], v[48:51], a[220:223], v[28:31]
    buffer_load_dwordx4 v210, s[16:19], s51 offen offset:0 lds
    s_waitcnt lgkmcnt(8)
    v_mfma_f32_16x16x32_bf16 v[16:19], v[52:55], a[224:227], v[16:19]
    ds_read_b64_tr_b16 v[72:73], v202 offset:40960
    s_add_u32 s43, s43, s62
    v_mfma_f32_16x16x32_bf16 v[20:23], v[52:55], a[228:231], v[20:23]
    ds_read_b64_tr_b16 v[74:75], v202 offset:43008
    s_add_u32 s44, s44, s62
    v_mfma_f32_16x16x32_bf16 v[24:27], v[52:55], a[232:235], v[24:27]
    s_add_u32 s45, s45, s62
    s_add_u32 s46, s46, s62
    v_mfma_f32_16x16x32_bf16 v[28:31], v[52:55], a[236:239], v[28:31]
    buffer_load_dwordx4 v211, s[16:19], s51 offen offset:1024 lds
    s_waitcnt vmcnt(13)
    s_barrier
    s_waitcnt lgkmcnt(8)
    v_mfma_f32_16x16x32_bf16 v[32:35], v[56:59], v[92:95], 0
    ds_read_b64_tr_b16 v[76:77], v202 offset:45056
    v_mfma_f32_16x16x32_bf16 v[36:39], v[56:59], v[96:99], 0
    ds_read_b64_tr_b16 v[78:79], v202 offset:47104
    s_add_u32 m0, s31, 98304
    v_mfma_f32_16x16x32_bf16 v[40:43], v[56:59], v[100:103], 0
    buffer_load_dwordx4 v210, s[16:19], s52 offen offset:0 lds
    v_mfma_f32_16x16x32_bf16 v[44:47], v[56:59], v[104:107], 0
    s_lshl_b32 s37, s70, 9
    s_waitcnt lgkmcnt(8)
    v_mfma_f32_16x16x32_bf16 v[32:35], v[60:63], a[0:3], v[32:35]
    ds_read_b64_tr_b16 v[48:49], v214 offset:49152
    v_mfma_f32_16x16x32_bf16 v[36:39], v[60:63], a[4:7], v[36:39]
    ds_read_b64_tr_b16 v[50:51], v214 offset:57344
    buffer_load_dwordx4 v211, s[16:19], s52 offen offset:1024 lds
    v_mfma_f32_16x16x32_bf16 v[40:43], v[60:63], a[8:11], v[40:43]
    v_cvt_pk_bf16_f32 v84, v16, v17
    v_mfma_f32_16x16x32_bf16 v[44:47], v[60:63], a[12:15], v[44:47]
    s_waitcnt lgkmcnt(8)
    v_mfma_f32_16x16x32_bf16 v[32:35], v[64:67], a[16:19], v[32:35]
    ds_read_b64_tr_b16 v[52:53], v217 offset:49152
    s_add_u32 m0, s31, 106496
    v_mfma_f32_16x16x32_bf16 v[36:39], v[64:67], a[20:23], v[36:39]
    ds_read_b64_tr_b16 v[54:55], v217 offset:57344
    v_cvt_pk_bf16_f32 v85, v18, v19
    v_mfma_f32_16x16x32_bf16 v[40:43], v[64:67], a[24:27], v[40:43]
    buffer_load_dwordx4 v210, s[16:19], s53 offen offset:0 lds
    v_mfma_f32_16x16x32_bf16 v[44:47], v[64:67], a[28:31], v[44:47]
    v_cvt_pk_bf16_f32 v86, v20, v21
    s_waitcnt lgkmcnt(8)
    v_mfma_f32_16x16x32_bf16 v[32:35], v[68:71], a[32:35], v[32:35]
    ds_read_b64_tr_b16 v[56:57], v224 offset:49152
    v_mfma_f32_16x16x32_bf16 v[36:39], v[68:71], a[36:39], v[36:39]
    ds_read_b64_tr_b16 v[58:59], v224 offset:57344
    buffer_load_dwordx4 v211, s[16:19], s53 offen offset:1024 lds
    v_mfma_f32_16x16x32_bf16 v[40:43], v[68:71], a[40:43], v[40:43]
    v_cvt_pk_bf16_f32 v87, v22, v23
    buffer_store_dwordx4 v[84:87], v221, s[20:23], s37 offen offset:0 sc1
    v_mfma_f32_16x16x32_bf16 v[44:47], v[68:71], a[44:47], v[44:47]
    s_waitcnt lgkmcnt(8)
    v_mfma_f32_16x16x32_bf16 v[32:35], v[72:75], a[48:51], v[32:35]
    ds_read_b64_tr_b16 v[60:61], v227 offset:49152
    s_add_u32 m0, s31, 114688
    v_mfma_f32_16x16x32_bf16 v[36:39], v[72:75], a[52:55], v[36:39]
    ds_read_b64_tr_b16 v[62:63], v227 offset:57344
    buffer_load_dwordx4 v210, s[16:19], s54 offen offset:0 lds
    v_mfma_f32_16x16x32_bf16 v[40:43], v[72:75], a[56:59], v[40:43]
    v_mfma_f32_16x16x32_bf16 v[44:47], v[72:75], a[60:63], v[44:47]
    s_waitcnt lgkmcnt(8)
    v_mfma_f32_16x16x32_bf16 v[32:35], v[76:79], a[64:67], v[32:35]
    ds_read_b64_tr_b16 v[64:65], v203 offset:0
    v_mfma_f32_16x16x32_bf16 v[36:39], v[76:79], a[68:71], v[36:39]
    ds_read_b64_tr_b16 v[66:67], v203 offset:2048
    buffer_load_dwordx4 v211, s[16:19], s54 offen offset:1024 lds
    v_mfma_f32_16x16x32_bf16 v[40:43], v[76:79], a[72:75], v[40:43]
    v_mfma_f32_16x16x32_bf16 v[44:47], v[76:79], a[76:79], v[44:47]
    s_waitcnt vmcnt(13)
    s_barrier
    s_waitcnt lgkmcnt(8)
    v_mfma_f32_16x16x32_bf16 v[32:35], v[48:51], v[116:119], v[32:35]
    ds_read_b64_tr_b16 v[68:69], v203 offset:4096
    v_mfma_f32_16x16x32_bf16 v[36:39], v[48:51], v[120:123], v[36:39]
    ds_read_b64_tr_b16 v[70:71], v203 offset:6144
    s_add_u32 m0, s31, 0
    v_mfma_f32_16x16x32_bf16 v[40:43], v[48:51], v[124:127], v[40:43]
    buffer_load_dwordx4 v210, s[16:19], s55 offen offset:0 lds
    v_mfma_f32_16x16x32_bf16 v[44:47], v[48:51], v[128:131], v[44:47]
    s_waitcnt lgkmcnt(8)
    v_mfma_f32_16x16x32_bf16 v[32:35], v[52:55], a[80:83], v[32:35]
    ds_read_b64_tr_b16 v[72:73], v215 offset:57344
    v_mfma_f32_16x16x32_bf16 v[36:39], v[52:55], a[84:87], v[36:39]
    ds_read_b64_tr_b16 v[74:75], v216 offset:0
    buffer_load_dwordx4 v211, s[16:19], s55 offen offset:1024 lds
    v_mfma_f32_16x16x32_bf16 v[40:43], v[52:55], a[88:91], v[40:43]
    v_cvt_pk_bf16_f32 v88, v24, v25
    v_mfma_f32_16x16x32_bf16 v[44:47], v[52:55], a[92:95], v[44:47]
    s_waitcnt lgkmcnt(8)
    v_mfma_f32_16x16x32_bf16 v[32:35], v[56:59], a[96:99], v[32:35]
    ds_read_b64_tr_b16 v[76:77], v222 offset:57344
    s_add_u32 m0, s31, 8192
    v_mfma_f32_16x16x32_bf16 v[36:39], v[56:59], a[100:103], v[36:39]
    ds_read_b64_tr_b16 v[78:79], v223 offset:0
    v_cvt_pk_bf16_f32 v89, v26, v27
    v_mfma_f32_16x16x32_bf16 v[40:43], v[56:59], a[104:107], v[40:43]
    buffer_load_dwordx4 v210, s[16:19], s56 offen offset:0 lds
    v_mfma_f32_16x16x32_bf16 v[44:47], v[56:59], a[108:111], v[44:47]
    v_cvt_pk_bf16_f32 v90, v28, v29
    s_waitcnt lgkmcnt(8)
    v_mfma_f32_16x16x32_bf16 v[32:35], v[60:63], a[112:115], v[32:35]
    ds_read_b64_tr_b16 v[48:49], v225 offset:57344
    v_mfma_f32_16x16x32_bf16 v[36:39], v[60:63], a[116:119], v[36:39]
    ds_read_b64_tr_b16 v[50:51], v226 offset:0
    buffer_load_dwordx4 v211, s[16:19], s56 offen offset:1024 lds
    v_mfma_f32_16x16x32_bf16 v[40:43], v[60:63], a[120:123], v[40:43]
    v_cvt_pk_bf16_f32 v91, v30, v31
    buffer_store_dwordx4 v[88:91], v221, s[20:23], s37 offen offset:1024 sc1
    v_mfma_f32_16x16x32_bf16 v[44:47], v[60:63], a[124:127], v[44:47]
    s_waitcnt lgkmcnt(8)
    v_mfma_f32_16x16x32_bf16 v[32:35], v[64:67], a[128:131], v[32:35]
    ds_read_b64_tr_b16 v[52:53], v246 offset:57344
    s_add_u32 m0, s31, 16384
    v_mfma_f32_16x16x32_bf16 v[36:39], v[64:67], a[132:135], v[36:39]
    ds_read_b64_tr_b16 v[54:55], v247 offset:0
    buffer_load_dwordx4 v210, s[16:19], s57 offen offset:0 lds
    v_mfma_f32_16x16x32_bf16 v[40:43], v[64:67], a[136:139], v[40:43]
    v_mfma_f32_16x16x32_bf16 v[44:47], v[64:67], a[140:143], v[44:47]
    s_waitcnt lgkmcnt(8)
    v_mfma_f32_16x16x32_bf16 v[32:35], v[68:71], a[144:147], v[32:35]
    ds_read_b64_tr_b16 v[56:57], v204 offset:8192
    v_mfma_f32_16x16x32_bf16 v[36:39], v[68:71], a[148:151], v[36:39]
    ds_read_b64_tr_b16 v[58:59], v204 offset:10240
    buffer_load_dwordx4 v211, s[16:19], s57 offen offset:1024 lds
    v_mfma_f32_16x16x32_bf16 v[40:43], v[68:71], a[152:155], v[40:43]
    v_mfma_f32_16x16x32_bf16 v[44:47], v[68:71], a[156:159], v[44:47]
    s_waitcnt vmcnt(14)
    s_barrier
    s_waitcnt lgkmcnt(8)
    v_mfma_f32_16x16x32_bf16 v[32:35], v[72:75], v[140:143], v[32:35]
    ds_read_b64_tr_b16 v[60:61], v204 offset:12288
    v_add_u32 v210, s73, v212
    v_mfma_f32_16x16x32_bf16 v[36:39], v[72:75], v[144:147], v[36:39]
    ds_read_b64_tr_b16 v[62:63], v204 offset:14336
    v_add_u32 v211, s73, v213
    v_mfma_f32_16x16x32_bf16 v[40:43], v[72:75], v[148:151], v[40:43]
    s_add_u32 m0, s31, 24576
    s_nop 0
    buffer_load_dwordx4 v210, s[16:19], s49 offen offset:0 lds
    v_mfma_f32_16x16x32_bf16 v[44:47], v[72:75], v[152:155], v[44:47]
    s_waitcnt lgkmcnt(8)
    v_mfma_f32_16x16x32_bf16 v[32:35], v[76:79], a[160:163], v[32:35]
    ds_read_b64_tr_b16 v[64:65], v215 offset:8192
    v_mfma_f32_16x16x32_bf16 v[36:39], v[76:79], a[164:167], v[36:39]
    ds_read_b64_tr_b16 v[66:67], v215 offset:16384
    buffer_load_dwordx4 v211, s[16:19], s49 offen offset:1024 lds
    v_mfma_f32_16x16x32_bf16 v[40:43], v[76:79], a[168:171], v[40:43]
    v_mfma_f32_16x16x32_bf16 v[44:47], v[76:79], a[172:175], v[44:47]
    s_waitcnt lgkmcnt(8)
    v_mfma_f32_16x16x32_bf16 v[32:35], v[48:51], a[176:179], v[32:35]
    ds_read_b64_tr_b16 v[68:69], v222 offset:8192
    s_add_u32 m0, s31, 32768
    v_mfma_f32_16x16x32_bf16 v[36:39], v[48:51], a[180:183], v[36:39]
    ds_read_b64_tr_b16 v[70:71], v222 offset:16384
    buffer_load_dwordx4 v210, s[16:19], s50 offen offset:0 lds
    v_mfma_f32_16x16x32_bf16 v[40:43], v[48:51], a[184:187], v[40:43]
    v_mfma_f32_16x16x32_bf16 v[44:47], v[48:51], a[188:191], v[44:47]
    s_waitcnt lgkmcnt(8)
    v_mfma_f32_16x16x32_bf16 v[32:35], v[52:55], a[192:195], v[32:35]
    ds_read_b64_tr_b16 v[72:73], v225 offset:8192
    v_mfma_f32_16x16x32_bf16 v[36:39], v[52:55], a[196:199], v[36:39]
    ds_read_b64_tr_b16 v[74:75], v225 offset:16384
    buffer_load_dwordx4 v211, s[16:19], s50 offen offset:1024 lds
    v_mfma_f32_16x16x32_bf16 v[40:43], v[52:55], a[200:203], v[40:43]
    v_mfma_f32_16x16x32_bf16 v[44:47], v[52:55], a[204:207], v[44:47]
    s_waitcnt lgkmcnt(8)
    v_mfma_f32_16x16x32_bf16 v[32:35], v[56:59], a[208:211], v[32:35]
    ds_read_b64_tr_b16 v[76:77], v246 offset:8192
    s_add_u32 m0, s31, 40960
    v_mfma_f32_16x16x32_bf16 v[36:39], v[56:59], a[212:215], v[36:39]
    ds_read_b64_tr_b16 v[78:79], v246 offset:16384
    buffer_load_dwordx4 v210, s[16:19], s51 offen offset:0 lds
    v_mfma_f32_16x16x32_bf16 v[40:43], v[56:59], a[216:219], v[40:43]
    v_mfma_f32_16x16x32_bf16 v[44:47], v[56:59], a[220:223], v[44:47]
    s_waitcnt lgkmcnt(8)
    v_mfma_f32_16x16x32_bf16 v[32:35], v[60:63], a[224:227], v[32:35]
L_pg15:
    s_cbranch_vccnz L_pg19
    ds_read_b64_tr_b16 v[48:49], v203 offset:24576
    v_mfma_f32_16x16x32_bf16 v[36:39], v[60:63], a[228:231], v[36:39]
    ds_read_b64_tr_b16 v[50:51], v203 offset:26624
    buffer_load_dwordx4 v211, s[16:19], s51 offen offset:1024 lds
    v_mfma_f32_16x16x32_bf16 v[40:43], v[60:63], a[232:235], v[40:43]
    v_mfma_f32_16x16x32_bf16 v[44:47], v[60:63], a[236:239], v[44:47]
    s_waitcnt vmcnt(13)
    s_barrier
    s_waitcnt lgkmcnt(8)
L_pg16:
    s_cbranch_vccnz L_pg20
    v_mfma_f32_16x16x32_bf16 v[16:19], v[64:67], v[92:95], 0
    ds_read_b64_tr_b16 v[52:53], v203 offset:28672
    v_mfma_f32_16x16x32_bf16 v[20:23], v[64:67], v[96:99], 0
    ds_read_b64_tr_b16 v[54:55], v203 offset:30720
    s_add_u32 m0, s31, 49152
    v_mfma_f32_16x16x32_bf16 v[24:27], v[64:67], v[100:103], 0
    buffer_load_dwordx4 v210, s[16:19], s52 offen offset:0 lds
    v_mfma_f32_16x16x32_bf16 v[28:31], v[64:67], v[104:107], 0
L_pg17:
    s_cbranch_vccnz L_walk_done
    s_lshl_b32 s37, s71, 9
    s_waitcnt lgkmcnt(8)
    v_mfma_f32_16x16x32_bf16 v[16:19], v[68:71], a[0:3], v[16:19]
    ds_read_b64_tr_b16 v[56:57], v215 offset:32768
    v_mfma_f32_16x16x32_bf16 v[20:23], v[68:71], a[4:7], v[20:23]
    ds_read_b64_tr_b16 v[58:59], v215 offset:40960
    buffer_load_dwordx4 v211, s[16:19], s52 offen offset:1024 lds
    v_mfma_f32_16x16x32_bf16 v[24:27], v[68:71], a[8:11], v[24:27]
    v_cvt_pk_bf16_f32 v84, v32, v33
    v_mfma_f32_16x16x32_bf16 v[28:31], v[68:71], a[12:15], v[28:31]
    s_waitcnt lgkmcnt(8)
    v_mfma_f32_16x16x32_bf16 v[16:19], v[72:75], a[16:19], v[16:19]
    ds_read_b64_tr_b16 v[60:61], v222 offset:32768
    s_add_u32 m0, s31, 57344
    v_mfma_f32_16x16x32_bf16 v[20:23], v[72:75], a[20:23], v[20:23]
    ds_read_b64_tr_b16 v[62:63], v222 offset:40960
    v_cvt_pk_bf16_f32 v85, v34, v35
    v_mfma_f32_16x16x32_bf16 v[24:27], v[72:75], a[24:27], v[24:27]
    buffer_load_dwordx4 v210, s[16:19], s53 offen offset:0 lds
    v_mfma_f32_16x16x32_bf16 v[28:31], v[72:75], a[28:31], v[28:31]
    v_cvt_pk_bf16_f32 v86, v36, v37
    s_waitcnt lgkmcnt(8)
    v_mfma_f32_16x16x32_bf16 v[16:19], v[76:79], a[32:35], v[16:19]
    ds_read_b64_tr_b16 v[64:65], v225 offset:32768
    v_mfma_f32_16x16x32_bf16 v[20:23], v[76:79], a[36:39], v[20:23]
    ds_read_b64_tr_b16 v[66:67], v225 offset:40960
    buffer_load_dwordx4 v211, s[16:19], s53 offen offset:1024 lds
    v_mfma_f32_16x16x32_bf16 v[24:27], v[76:79], a[40:43], v[24:27]
    v_cvt_pk_bf16_f32 v87, v38, v39
    buffer_store_dwordx4 v[84:87], v221, s[20:23], s37 offen offset:0 sc1
    v_mfma_f32_16x16x32_bf16 v[28:31], v[76:79], a[44:47], v[28:31]
    s_waitcnt lgkmcnt(8)
    v_mfma_f32_16x16x32_bf16 v[16:19], v[48:51], a[48:51], v[16:19]
    ds_read_b64_tr_b16 v[68:69], v246 offset:32768
    s_add_u32 m0, s31, 65536
    v_mfma_f32_16x16x32_bf16 v[20:23], v[48:51], a[52:55], v[20:23]
    ds_read_b64_tr_b16 v[70:71], v246 offset:40960
    buffer_load_dwordx4 v210, s[16:19], s54 offen offset:0 lds
    v_mfma_f32_16x16x32_bf16 v[24:27], v[48:51], a[56:59], v[24:27]
    v_mfma_f32_16x16x32_bf16 v[28:31], v[48:51], a[60:63], v[28:31]
    s_waitcnt lgkmcnt(8)
    v_mfma_f32_16x16x32_bf16 v[16:19], v[52:55], a[64:67], v[16:19]
    ds_read_b64_tr_b16 v[72:73], v203 offset:49152
    v_mfma_f32_16x16x32_bf16 v[20:23], v[52:55], a[68:71], v[20:23]
    ds_read_b64_tr_b16 v[74:75], v203 offset:51200
    buffer_load_dwordx4 v211, s[16:19], s54 offen offset:1024 lds
    v_mfma_f32_16x16x32_bf16 v[24:27], v[52:55], a[72:75], v[24:27]
    v_mfma_f32_16x16x32_bf16 v[28:31], v[52:55], a[76:79], v[28:31]
    s_waitcnt vmcnt(13)
    s_barrier
    s_waitcnt lgkmcnt(8)
    v_mfma_f32_16x16x32_bf16 v[16:19], v[56:59], v[116:119], v[16:19]
    ds_read_b64_tr_b16 v[76:77], v203 offset:53248
    s_add_u32 s62, s36, 4
    v_mfma_f32_16x16x32_bf16 v[20:23], v[56:59], v[120:123], v[20:23]
    ds_read_b64_tr_b16 v[78:79], v203 offset:55296
    s_add_u32 m0, s31, 122880
    v_mfma_f32_16x16x32_bf16 v[24:27], v[56:59], v[124:127], v[24:27]
    v_mov_b32 v237, s62
    buffer_load_dwordx4 v210, s[16:19], s55 offen offset:0 lds
    v_mfma_f32_16x16x32_bf16 v[28:31], v[56:59], v[128:131], v[28:31]
    buffer_store_dword v237, v236, s[20:23], 0 offen sc1
    s_waitcnt lgkmcnt(8)
    v_mfma_f32_16x16x32_bf16 v[16:19], v[60:63], a[80:83], v[16:19]
    ds_read_b64_tr_b16 v[48:49], v214 offset:0
    v_mfma_f32_16x16x32_bf16 v[20:23], v[60:63], a[84:87], v[20:23]
    ds_read_b64_tr_b16 v[50:51], v214 offset:8192
    buffer_load_dwordx4 v211, s[16:19], s55 offen offset:1024 lds
    v_mfma_f32_16x16x32_bf16 v[24:27], v[60:63], a[88:91], v[24:27]
    v_cvt_pk_bf16_f32 v88, v40, v41
    v_mfma_f32_16x16x32_bf16 v[28:31], v[60:63], a[92:95], v[28:31]
    s_waitcnt lgkmcnt(8)
    v_mfma_f32_16x16x32_bf16 v[16:19], v[64:67], a[96:99], v[16:19]
    ds_read_b64_tr_b16 v[52:53], v217 offset:0
    s_add_u32 m0, s31, 131072
    v_mfma_f32_16x16x32_bf16 v[20:23], v[64:67], a[100:103], v[20:23]
    ds_read_b64_tr_b16 v[54:55], v217 offset:8192
    v_cvt_pk_bf16_f32 v89, v42, v43
    v_mfma_f32_16x16x32_bf16 v[24:27], v[64:67], a[104:107], v[24:27]
    buffer_load_dwordx4 v210, s[16:19], s56 offen offset:0 lds
    v_mfma_f32_16x16x32_bf16 v[28:31], v[64:67], a[108:111], v[28:31]
    v_cvt_pk_bf16_f32 v90, v44, v45
    s_waitcnt lgkmcnt(8)
    v_mfma_f32_16x16x32_bf16 v[16:19], v[68:71], a[112:115], v[16:19]
    ds_read_b64_tr_b16 v[56:57], v224 offset:0
    v_mfma_f32_16x16x32_bf16 v[20:23], v[68:71], a[116:119], v[20:23]
    ds_read_b64_tr_b16 v[58:59], v224 offset:8192
    buffer_load_dwordx4 v211, s[16:19], s56 offen offset:1024 lds
    v_mfma_f32_16x16x32_bf16 v[24:27], v[68:71], a[120:123], v[24:27]
    v_cvt_pk_bf16_f32 v91, v46, v47
    buffer_store_dwordx4 v[88:91], v221, s[20:23], s37 offen offset:1024 sc1
    v_mfma_f32_16x16x32_bf16 v[28:31], v[68:71], a[124:127], v[28:31]
    s_waitcnt lgkmcnt(8)
    v_mfma_f32_16x16x32_bf16 v[16:19], v[72:75], a[128:131], v[16:19]
    ds_read_b64_tr_b16 v[60:61], v227 offset:0
    s_add_u32 m0, s31, 139264
    v_mfma_f32_16x16x32_bf16 v[20:23], v[72:75], a[132:135], v[20:23]
    ds_read_b64_tr_b16 v[62:63], v227 offset:8192
    buffer_load_dwordx4 v210, s[16:19], s57 offen offset:0 lds
    v_mfma_f32_16x16x32_bf16 v[24:27], v[72:75], a[136:139], v[24:27]
    v_mfma_f32_16x16x32_bf16 v[28:31], v[72:75], a[140:143], v[28:31]
    s_waitcnt lgkmcnt(8)
    v_mfma_f32_16x16x32_bf16 v[16:19], v[76:79], a[144:147], v[16:19]
    ds_read_b64_tr_b16 v[64:65], v202 offset:16384
    v_mfma_f32_16x16x32_bf16 v[20:23], v[76:79], a[148:151], v[20:23]
    ds_read_b64_tr_b16 v[66:67], v202 offset:18432
    buffer_load_dwordx4 v211, s[16:19], s57 offen offset:1024 lds
    v_mfma_f32_16x16x32_bf16 v[24:27], v[76:79], a[152:155], v[24:27]
    v_mfma_f32_16x16x32_bf16 v[28:31], v[76:79], a[156:159], v[28:31]
    s_waitcnt vmcnt(15)
    s_barrier
    s_waitcnt lgkmcnt(8)
    v_mfma_f32_16x16x32_bf16 v[16:19], v[48:51], v[140:143], v[16:19]
    ds_read_b64_tr_b16 v[68:69], v202 offset:20480
    v_add_u32 v210, s74, v212
    v_mfma_f32_16x16x32_bf16 v[20:23], v[48:51], v[144:147], v[20:23]
    ds_read_b64_tr_b16 v[70:71], v202 offset:22528
    v_add_u32 v211, s74, v213
    v_mfma_f32_16x16x32_bf16 v[24:27], v[48:51], v[148:151], v[24:27]
    s_add_u32 m0, s31, 73728
    s_nop 0
    buffer_load_dwordx4 v210, s[16:19], s49 offen offset:0 lds
    v_mfma_f32_16x16x32_bf16 v[28:31], v[48:51], v[152:155], v[28:31]
    s_waitcnt lgkmcnt(8)
    v_mfma_f32_16x16x32_bf16 v[16:19], v[52:55], a[160:163], v[16:19]
    ds_read_b64_tr_b16 v[72:73], v214 offset:24576
    v_mfma_f32_16x16x32_bf16 v[20:23], v[52:55], a[164:167], v[20:23]
    ds_read_b64_tr_b16 v[74:75], v214 offset:32768
    buffer_load_dwordx4 v211, s[16:19], s49 offen offset:1024 lds
    v_mfma_f32_16x16x32_bf16 v[24:27], v[52:55], a[168:171], v[24:27]
    v_mfma_f32_16x16x32_bf16 v[28:31], v[52:55], a[172:175], v[28:31]
    s_waitcnt lgkmcnt(8)
    v_mfma_f32_16x16x32_bf16 v[16:19], v[56:59], a[176:179], v[16:19]
    ds_read_b64_tr_b16 v[76:77], v217 offset:24576
    s_add_u32 m0, s31, 81920
    v_mfma_f32_16x16x32_bf16 v[20:23], v[56:59], a[180:183], v[20:23]
    ds_read_b64_tr_b16 v[78:79], v217 offset:32768
    buffer_load_dwordx4 v210, s[16:19], s50 offen offset:0 lds
    v_mfma_f32_16x16x32_bf16 v[24:27], v[56:59], a[184:187], v[24:27]
    v_mfma_f32_16x16x32_bf16 v[28:31], v[56:59], a[188:191], v[28:31]
    s_waitcnt lgkmcnt(8)
    v_mfma_f32_16x16x32_bf16 v[16:19], v[60:63], a[192:195], v[16:19]
    ds_read_b64_tr_b16 v[48:49], v224 offset:24576
    v_mfma_f32_16x16x32_bf16 v[20:23], v[60:63], a[196:199], v[20:23]
    ds_read_b64_tr_b16 v[50:51], v224 offset:32768
    buffer_load_dwordx4 v211, s[16:19], s50 offen offset:1024 lds
    v_mfma_f32_16x16x32_bf16 v[24:27], v[60:63], a[200:203], v[24:27]
    v_mfma_f32_16x16x32_bf16 v[28:31], v[60:63], a[204:207], v[28:31]
    s_waitcnt lgkmcnt(8)
    v_mfma_f32_16x16x32_bf16 v[16:19], v[64:67], a[208:211], v[16:19]
    ds_read_b64_tr_b16 v[52:53], v227 offset:24576
    s_add_u32 m0, s31, 90112
    v_mfma_f32_16x16x32_bf16 v[20:23], v[64:67], a[212:215], v[20:23]
    ds_read_b64_tr_b16 v[54:55], v227 offset:32768
    buffer_load_dwordx4 v210, s[16:19], s51 offen offset:0 lds
    v_mfma_f32_16x16x32_bf16 v[24:27], v[64:67], a[216:219], v[24:27]
    v_mfma_f32_16x16x32_bf16 v[28:31], v[64:67], a[220:223], v[28:31]
    s_waitcnt lgkmcnt(8)
    v_mfma_f32_16x16x32_bf16 v[16:19], v[68:71], a[224:227], v[16:19]
    ds_read_b64_tr_b16 v[56:57], v202 offset:40960
    v_mfma_f32_16x16x32_bf16 v[20:23], v[68:71], a[228:231], v[20:23]
    ds_read_b64_tr_b16 v[58:59], v202 offset:43008
    buffer_load_dwordx4 v211, s[16:19], s51 offen offset:1024 lds
    v_mfma_f32_16x16x32_bf16 v[24:27], v[68:71], a[232:235], v[24:27]
    v_mfma_f32_16x16x32_bf16 v[28:31], v[68:71], a[236:239], v[28:31]
    s_waitcnt vmcnt(14)
    s_barrier
    s_waitcnt lgkmcnt(8)
    v_mfma_f32_16x16x32_bf16 v[32:35], v[72:75], v[92:95], 0
    ds_read_b64_tr_b16 v[60:61], v202 offset:45056
    v_mfma_f32_16x16x32_bf16 v[36:39], v[72:75], v[96:99], 0
    ds_read_b64_tr_b16 v[62:63], v202 offset:47104
    s_add_u32 m0, s31, 98304
    v_mfma_f32_16x16x32_bf16 v[40:43], v[72:75], v[100:103], 0
    buffer_load_dwordx4 v210, s[16:19], s52 offen offset:0 lds
    v_mfma_f32_16x16x32_bf16 v[44:47], v[72:75], v[104:107], 0
    s_lshl_b32 s37, s72, 9
    s_waitcnt lgkmcnt(8)
    v_mfma_f32_16x16x32_bf16 v[32:35], v[76:79], a[0:3], v[32:35]
    ds_read_b64_tr_b16 v[64:65], v214 offset:49152
    v_mfma_f32_16x16x32_bf16 v[36:39], v[76:79], a[4:7], v[36:39]
    ds_read_b64_tr_b16 v[66:67], v214 offset:57344
    buffer_load_dwordx4 v211, s[16:19], s52 offen offset:1024 lds
    v_mfma_f32_16x16x32_bf16 v[40:43], v[76:79], a[8:11], v[40:43]
    v_cvt_pk_bf16_f32 v84, v16, v17
    v_mfma_f32_16x16x32_bf16 v[44:47], v[76:79], a[12:15], v[44:47]
    s_waitcnt lgkmcnt(8)
    v_mfma_f32_16x16x32_bf16 v[32:35], v[48:51], a[16:19], v[32:35]
    ds_read_b64_tr_b16 v[68:69], v217 offset:49152
    s_add_u32 m0, s31, 106496
    v_mfma_f32_16x16x32_bf16 v[36:39], v[48:51], a[20:23], v[36:39]
    ds_read_b64_tr_b16 v[70:71], v217 offset:57344
    v_cvt_pk_bf16_f32 v85, v18, v19
    v_mfma_f32_16x16x32_bf16 v[40:43], v[48:51], a[24:27], v[40:43]
    buffer_load_dwordx4 v210, s[16:19], s53 offen offset:0 lds
    v_mfma_f32_16x16x32_bf16 v[44:47], v[48:51], a[28:31], v[44:47]
    v_cvt_pk_bf16_f32 v86, v20, v21
    s_waitcnt lgkmcnt(8)
    v_mfma_f32_16x16x32_bf16 v[32:35], v[52:55], a[32:35], v[32:35]
    ds_read_b64_tr_b16 v[72:73], v224 offset:49152
    v_mfma_f32_16x16x32_bf16 v[36:39], v[52:55], a[36:39], v[36:39]
    ds_read_b64_tr_b16 v[74:75], v224 offset:57344
    buffer_load_dwordx4 v211, s[16:19], s53 offen offset:1024 lds
    v_mfma_f32_16x16x32_bf16 v[40:43], v[52:55], a[40:43], v[40:43]
    v_cvt_pk_bf16_f32 v87, v22, v23
    buffer_store_dwordx4 v[84:87], v221, s[20:23], s37 offen offset:0 sc1
    v_mfma_f32_16x16x32_bf16 v[44:47], v[52:55], a[44:47], v[44:47]
    s_waitcnt lgkmcnt(8)
    v_mfma_f32_16x16x32_bf16 v[32:35], v[56:59], a[48:51], v[32:35]
    ds_read_b64_tr_b16 v[76:77], v227 offset:49152
    s_add_u32 m0, s31, 114688
    v_mfma_f32_16x16x32_bf16 v[36:39], v[56:59], a[52:55], v[36:39]
    ds_read_b64_tr_b16 v[78:79], v227 offset:57344
    buffer_load_dwordx4 v210, s[16:19], s54 offen offset:0 lds
    v_mfma_f32_16x16x32_bf16 v[40:43], v[56:59], a[56:59], v[40:43]
    v_mfma_f32_16x16x32_bf16 v[44:47], v[56:59], a[60:63], v[44:47]
    s_waitcnt lgkmcnt(8)
    v_mfma_f32_16x16x32_bf16 v[32:35], v[60:63], a[64:67], v[32:35]
    ds_read_b64_tr_b16 v[48:49], v203 offset:0
    v_mfma_f32_16x16x32_bf16 v[36:39], v[60:63], a[68:71], v[36:39]
    ds_read_b64_tr_b16 v[50:51], v203 offset:2048
    buffer_load_dwordx4 v211, s[16:19], s54 offen offset:1024 lds
    v_mfma_f32_16x16x32_bf16 v[40:43], v[60:63], a[72:75], v[40:43]
    v_mfma_f32_16x16x32_bf16 v[44:47], v[60:63], a[76:79], v[44:47]
    s_waitcnt vmcnt(13)
    s_barrier
    s_waitcnt lgkmcnt(8)
    v_mfma_f32_16x16x32_bf16 v[32:35], v[64:67], v[116:119], v[32:35]
    ds_read_b64_tr_b16 v[52:53], v203 offset:4096
    v_mfma_f32_16x16x32_bf16 v[36:39], v[64:67], v[120:123], v[36:39]
    ds_read_b64_tr_b16 v[54:55], v203 offset:6144
    s_add_u32 m0, s31, 0
    v_mfma_f32_16x16x32_bf16 v[40:43], v[64:67], v[124:127], v[40:43]
    buffer_load_dwordx4 v210, s[16:19], s55 offen offset:0 lds
    v_mfma_f32_16x16x32_bf16 v[44:47], v[64:67], v[128:131], v[44:47]
    s_waitcnt lgkmcnt(8)
    v_mfma_f32_16x16x32_bf16 v[32:35], v[68:71], a[80:83], v[32:35]
    ds_read_b64_tr_b16 v[56:57], v215 offset:57344
    v_mfma_f32_16x16x32_bf16 v[36:39], v[68:71], a[84:87], v[36:39]
    ds_read_b64_tr_b16 v[58:59], v216 offset:0
    buffer_load_dwordx4 v211, s[16:19], s55 offen offset:1024 lds
    v_mfma_f32_16x16x32_bf16 v[40:43], v[68:71], a[88:91], v[40:43]
    v_cvt_pk_bf16_f32 v88, v24, v25
    v_mfma_f32_16x16x32_bf16 v[44:47], v[68:71], a[92:95], v[44:47]
    s_waitcnt lgkmcnt(8)
    v_mfma_f32_16x16x32_bf16 v[32:35], v[72:75], a[96:99], v[32:35]
    ds_read_b64_tr_b16 v[60:61], v222 offset:57344
    s_add_u32 m0, s31, 8192
    v_mfma_f32_16x16x32_bf16 v[36:39], v[72:75], a[100:103], v[36:39]
    ds_read_b64_tr_b16 v[62:63], v223 offset:0
    v_cvt_pk_bf16_f32 v89, v26, v27
    v_mfma_f32_16x16x32_bf16 v[40:43], v[72:75], a[104:107], v[40:43]
    buffer_load_dwordx4 v210, s[16:19], s56 offen offset:0 lds
    v_mfma_f32_16x16x32_bf16 v[44:47], v[72:75], a[108:111], v[44:47]
    v_cvt_pk_bf16_f32 v90, v28, v29
    s_waitcnt lgkmcnt(8)
    v_mfma_f32_16x16x32_bf16 v[32:35], v[76:79], a[112:115], v[32:35]
    ds_read_b64_tr_b16 v[64:65], v225 offset:57344
    v_mfma_f32_16x16x32_bf16 v[36:39], v[76:79], a[116:119], v[36:39]
    ds_read_b64_tr_b16 v[66:67], v226 offset:0
    buffer_load_dwordx4 v211, s[16:19], s56 offen offset:1024 lds
    v_mfma_f32_16x16x32_bf16 v[40:43], v[76:79], a[120:123], v[40:43]
    v_cvt_pk_bf16_f32 v91, v30, v31
    buffer_store_dwordx4 v[88:91], v221, s[20:23], s37 offen offset:1024 sc1
    v_mfma_f32_16x16x32_bf16 v[44:47], v[76:79], a[124:127], v[44:47]
    s_waitcnt lgkmcnt(8)
    v_mfma_f32_16x16x32_bf16 v[32:35], v[48:51], a[128:131], v[32:35]
    ds_read_b64_tr_b16 v[68:69], v246 offset:57344
    s_add_u32 m0, s31, 16384
    v_mfma_f32_16x16x32_bf16 v[36:39], v[48:51], a[132:135], v[36:39]
    ds_read_b64_tr_b16 v[70:71], v247 offset:0
    buffer_load_dwordx4 v210, s[16:19], s57 offen offset:0 lds
    v_mfma_f32_16x16x32_bf16 v[40:43], v[48:51], a[136:139], v[40:43]
    v_mfma_f32_16x16x32_bf16 v[44:47], v[48:51], a[140:143], v[44:47]
    s_waitcnt lgkmcnt(8)
    v_mfma_f32_16x16x32_bf16 v[32:35], v[52:55], a[144:147], v[32:35]
    ds_read_b64_tr_b16 v[72:73], v204 offset:8192
    v_mfma_f32_16x16x32_bf16 v[36:39], v[52:55], a[148:151], v[36:39]
    ds_read_b64_tr_b16 v[74:75], v204 offset:10240
    buffer_load_dwordx4 v211, s[16:19], s57 offen offset:1024 lds
    v_mfma_f32_16x16x32_bf16 v[40:43], v[52:55], a[152:155], v[40:43]
    v_mfma_f32_16x16x32_bf16 v[44:47], v[52:55], a[156:159], v[44:47]
    s_waitcnt vmcnt(14)
    s_barrier
    s_waitcnt lgkmcnt(8)
    v_mfma_f32_16x16x32_bf16 v[32:35], v[56:59], v[140:143], v[32:35]
    ds_read_b64_tr_b16 v[76:77], v204 offset:12288
    v_add_u32 v210, s75, v212
    v_mfma_f32_16x16x32_bf16 v[36:39], v[56:59], v[144:147], v[36:39]
    ds_read_b64_tr_b16 v[78:79], v204 offset:14336
    v_add_u32 v211, s75, v213
    v_mfma_f32_16x16x32_bf16 v[40:43], v[56:59], v[148:151], v[40:43]
    s_add_u32 m0, s31, 24576
    s_nop 0
    buffer_load_dwordx4 v210, s[16:19], s49 offen offset:0 lds
    v_mfma_f32_16x16x32_bf16 v[44:47], v[56:59], v[152:155], v[44:47]
    s_waitcnt lgkmcnt(8)
    v_mfma_f32_16x16x32_bf16 v[32:35], v[60:63], a[160:163], v[32:35]
    ds_read_b64_tr_b16 v[48:49], v215 offset:8192
    v_mfma_f32_16x16x32_bf16 v[36:39], v[60:63], a[164:167], v[36:39]
    ds_read_b64_tr_b16 v[50:51], v215 offset:16384
    buffer_load_dwordx4 v211, s[16:19], s49 offen offset:1024 lds
    v_mfma_f32_16x16x32_bf16 v[40:43], v[60:63], a[168:171], v[40:43]
    v_mfma_f32_16x16x32_bf16 v[44:47], v[60:63], a[172:175], v[44:47]
    s_waitcnt lgkmcnt(8)
    v_mfma_f32_16x16x32_bf16 v[32:35], v[64:67], a[176:179], v[32:35]
    ds_read_b64_tr_b16 v[52:53], v222 offset:8192
    s_add_u32 m0, s31, 32768
    v_mfma_f32_16x16x32_bf16 v[36:39], v[64:67], a[180:183], v[36:39]
    ds_read_b64_tr_b16 v[54:55], v222 offset:16384
    buffer_load_dwordx4 v210, s[16:19], s50 offen offset:0 lds
    v_mfma_f32_16x16x32_bf16 v[40:43], v[64:67], a[184:187], v[40:43]
    v_mfma_f32_16x16x32_bf16 v[44:47], v[64:67], a[188:191], v[44:47]
    s_waitcnt lgkmcnt(8)
    v_mfma_f32_16x16x32_bf16 v[32:35], v[68:71], a[192:195], v[32:35]
    ds_read_b64_tr_b16 v[56:57], v225 offset:8192
    v_mfma_f32_16x16x32_bf16 v[36:39], v[68:71], a[196:199], v[36:39]
    ds_read_b64_tr_b16 v[58:59], v225 offset:16384
    buffer_load_dwordx4 v211, s[16:19], s50 offen offset:1024 lds
    v_mfma_f32_16x16x32_bf16 v[40:43], v[68:71], a[200:203], v[40:43]
    v_mfma_f32_16x16x32_bf16 v[44:47], v[68:71], a[204:207], v[44:47]
    s_waitcnt lgkmcnt(8)
    v_mfma_f32_16x16x32_bf16 v[32:35], v[72:75], a[208:211], v[32:35]
    ds_read_b64_tr_b16 v[60:61], v246 offset:8192
    s_add_u32 m0, s31, 40960
    v_mfma_f32_16x16x32_bf16 v[36:39], v[72:75], a[212:215], v[36:39]
    ds_read_b64_tr_b16 v[62:63], v246 offset:16384
    buffer_load_dwordx4 v210, s[16:19], s51 offen offset:0 lds
    v_mfma_f32_16x16x32_bf16 v[40:43], v[72:75], a[216:219], v[40:43]
    buffer_load_dword v239, v238, s[20:23], 0 offen sc1
    v_mfma_f32_16x16x32_bf16 v[44:47], v[72:75], a[220:223], v[44:47]
    s_waitcnt lgkmcnt(8)
    v_mfma_f32_16x16x32_bf16 v[32:35], v[76:79], a[224:227], v[32:35]
    ds_read_b64_tr_b16 v[64:65], v203 offset:24576
    v_mfma_f32_16x16x32_bf16 v[36:39], v[76:79], a[228:231], v[36:39]
    ds_read_b64_tr_b16 v[66:67], v203 offset:26624
    buffer_load_dwordx4 v211, s[16:19], s51 offen offset:1024 lds
    v_mfma_f32_16x16x32_bf16 v[40:43], v[76:79], a[232:235], v[40:43]
    v_mfma_f32_16x16x32_bf16 v[44:47], v[76:79], a[236:239], v[44:47]
    s_waitcnt vmcnt(14)
    s_barrier
    s_waitcnt lgkmcnt(8)
    v_mfma_f32_16x16x32_bf16 v[16:19], v[48:51], v[92:95], 0
    ds_read_b64_tr_b16 v[68:69], v203 offset:28672
    v_mfma_f32_16x16x32_bf16 v[20:23], v[48:51], v[96:99], 0
    ds_read_b64_tr_b16 v[70:71], v203 offset:30720
    s_add_u32 m0, s31, 49152
    v_mfma_f32_16x16x32_bf16 v[24:27], v[48:51], v[100:103], 0
    buffer_load_dwordx4 v210, s[16:19], s52 offen offset:0 lds
    v_mfma_f32_16x16x32_bf16 v[28:31], v[48:51], v[104:107], 0
    s_lshl_b32 s37, s73, 9
    s_waitcnt lgkmcnt(8)
    v_mfma_f32_16x16x32_bf16 v[16:19], v[52:55], a[0:3], v[16:19]
    ds_read_b64_tr_b16 v[72:73], v215 offset:32768
    v_mfma_f32_16x16x32_bf16 v[20:23], v[52:55], a[4:7], v[20:23]
    ds_read_b64_tr_b16 v[74:75], v215 offset:40960
    buffer_load_dwordx4 v211, s[16:19], s52 offen offset:1024 lds
    v_mfma_f32_16x16x32_bf16 v[24:27], v[52:55], a[8:11], v[24:27]
    v_cvt_pk_bf16_f32 v84, v32, v33
    v_mfma_f32_16x16x32_bf16 v[28:31], v[52:55], a[12:15], v[28:31]
    s_waitcnt lgkmcnt(8)
    v_mfma_f32_16x16x32_bf16 v[16:19], v[56:59], a[16:19], v[16:19]
    ds_read_b64_tr_b16 v[76:77], v222 offset:32768
    s_add_u32 m0, s31, 57344
    v_mfma_f32_16x16x32_bf16 v[20:23], v[56:59], a[20:23], v[20:23]
    ds_read_b64_tr_b16 v[78:79], v222 offset:40960
    v_cvt_pk_bf16_f32 v85, v34, v35
    v_mfma_f32_16x16x32_bf16 v[24:27], v[56:59], a[24:27], v[24:27]
    buffer_load_dwordx4 v210, s[16:19], s53 offen offset:0 lds
    v_mfma_f32_16x16x32_bf16 v[28:31], v[56:59], a[28:31], v[28:31]
    v_cvt_pk_bf16_f32 v86, v36, v37
    s_waitcnt lgkmcnt(8)
    v_mfma_f32_16x16x32_bf16 v[16:19], v[60:63], a[32:35], v[16:19]
    ds_read_b64_tr_b16 v[48:49], v225 offset:32768
    v_mfma_f32_16x16x32_bf16 v[20:23], v[60:63], a[36:39], v[20:23]
    ds_read_b64_tr_b16 v[50:51], v225 offset:40960
    buffer_load_dwordx4 v211, s[16:19], s53 offen offset:1024 lds
    v_mfma_f32_16x16x32_bf16 v[24:27], v[60:63], a[40:43], v[24:27]
    v_cvt_pk_bf16_f32 v87, v38, v39
    buffer_store_dwordx4 v[84:87], v221, s[20:23], s37 offen offset:0 sc1
    v_mfma_f32_16x16x32_bf16 v[28:31], v[60:63], a[44:47], v[28:31]
    s_waitcnt lgkmcnt(8)
    v_mfma_f32_16x16x32_bf16 v[16:19], v[64:67], a[48:51], v[16:19]
    ds_read_b64_tr_b16 v[52:53], v246 offset:32768
    s_add_u32 m0, s31, 65536
    v_mfma_f32_16x16x32_bf16 v[20:23], v[64:67], a[52:55], v[20:23]
    ds_read_b64_tr_b16 v[54:55], v246 offset:40960
    buffer_load_dwordx4 v210, s[16:19], s54 offen offset:0 lds
    v_mfma_f32_16x16x32_bf16 v[24:27], v[64:67], a[56:59], v[24:27]
    v_mfma_f32_16x16x32_bf16 v[28:31], v[64:67], a[60:63], v[28:31]
    s_waitcnt lgkmcnt(8)
    v_mfma_f32_16x16x32_bf16 v[16:19], v[68:71], a[64:67], v[16:19]
    ds_read_b64_tr_b16 v[56:57], v203 offset:49152
    v_mfma_f32_16x16x32_bf16 v[20:23], v[68:71], a[68:71], v[20:23]
    ds_read_b64_tr_b16 v[58:59], v203 offset:51200
    buffer_load_dwordx4 v211, s[16:19], s54 offen offset:1024 lds
    v_mfma_f32_16x16x32_bf16 v[24:27], v[68:71], a[72:75], v[24:27]
    v_mfma_f32_16x16x32_bf16 v[28:31], v[68:71], a[76:79], v[28:31]
    s_waitcnt vmcnt(14)
    s_barrier
    s_waitcnt lgkmcnt(8)
    v_mfma_f32_16x16x32_bf16 v[16:19], v[72:75], v[116:119], v[16:19]
    ds_read_b64_tr_b16 v[60:61], v203 offset:53248
    s_add_u32 s62, s36, 6
    v_mfma_f32_16x16x32_bf16 v[20:23], v[72:75], v[120:123], v[20:23]
    ds_read_b64_tr_b16 v[62:63], v203 offset:55296
    s_add_u32 m0, s31, 122880
    v_mfma_f32_16x16x32_bf16 v[24:27], v[72:75], v[124:127], v[24:27]
    v_mov_b32 v237, s62
    buffer_load_dwordx4 v210, s[16:19], s55 offen offset:0 lds
    v_mfma_f32_16x16x32_bf16 v[28:31], v[72:75], v[128:131], v[28:31]
    buffer_store_dword v237, v236, s[20:23], 0 offen sc1
    s_waitcnt lgkmcnt(8)
    v_mfma_f32_16x16x32_bf16 v[16:19], v[76:79], a[80:83], v[16:19]
    ds_read_b64_tr_b16 v[64:65], v214 offset:0
    v_mfma_f32_16x16x32_bf16 v[20:23], v[76:79], a[84:87], v[20:23]
    ds_read_b64_tr_b16 v[66:67], v214 offset:8192
    buffer_load_dwordx4 v211, s[16:19], s55 offen offset:1024 lds
    v_mfma_f32_16x16x32_bf16 v[24:27], v[76:79], a[88:91], v[24:27]
    v_cvt_pk_bf16_f32 v88, v40, v41
    v_mfma_f32_16x16x32_bf16 v[28:31], v[76:79], a[92:95], v[28:31]
    s_waitcnt lgkmcnt(8)
    v_mfma_f32_16x16x32_bf16 v[16:19], v[48:51], a[96:99], v[16:19]
    ds_read_b64_tr_b16 v[68:69], v217 offset:0
    s_add_u32 m0, s31, 131072
    v_mfma_f32_16x16x32_bf16 v[20:23], v[48:51], a[100:103], v[20:23]
    ds_read_b64_tr_b16 v[70:71], v217 offset:8192
    v_cvt_pk_bf16_f32 v89, v42, v43
    v_mfma_f32_16x16x32_bf16 v[24:27], v[48:51], a[104:107], v[24:27]
    buffer_load_dwordx4 v210, s[16:19], s56 offen offset:0 lds
    v_mfma_f32_16x16x32_bf16 v[28:31], v[48:51], a[108:111], v[28:31]
    v_cvt_pk_bf16_f32 v90, v44, v45
    s_waitcnt lgkmcnt(8)
    v_mfma_f32_16x16x32_bf16 v[16:19], v[52:55], a[112:115], v[16:19]
    ds_read_b64_tr_b16 v[72:73], v224 offset:0
    v_mfma_f32_16x16x32_bf16 v[20:23], v[52:55], a[116:119], v[20:23]
    ds_read_b64_tr_b16 v[74:75], v224 offset:8192
    buffer_load_dwordx4 v211, s[16:19], s56 offen offset:1024 lds
    v_mfma_f32_16x16x32_bf16 v[24:27], v[52:55], a[120:123], v[24:27]
    v_cvt_pk_bf16_f32 v91, v46, v47
    buffer_store_dwordx4 v[88:91], v221, s[20:23], s37 offen offset:1024 sc1
    v_mfma_f32_16x16x32_bf16 v[28:31], v[52:55], a[124:127], v[28:31]
    s_waitcnt lgkmcnt(8)
    v_mfma_f32_16x16x32_bf16 v[16:19], v[56:59], a[128:131], v[16:19]
    ds_read_b64_tr_b16 v[76:77], v227 offset:0
    s_add_u32 m0, s31, 139264
    v_mfma_f32_16x16x32_bf16 v[20:23], v[56:59], a[132:135], v[20:23]
    ds_read_b64_tr_b16 v[78:79], v227 offset:8192
    buffer_load_dwordx4 v210, s[16:19], s57 offen offset:0 lds
    v_mfma_f32_16x16x32_bf16 v[24:27], v[56:59], a[136:139], v[24:27]
    v_mfma_f32_16x16x32_bf16 v[28:31], v[56:59], a[140:143], v[28:31]
    s_waitcnt lgkmcnt(8)
    v_mfma_f32_16x16x32_bf16 v[16:19], v[60:63], a[144:147], v[16:19]
    ds_read_b64_tr_b16 v[48:49], v202 offset:16384
    v_mfma_f32_16x16x32_bf16 v[20:23], v[60:63], a[148:151], v[20:23]
    ds_read_b64_tr_b16 v[50:51], v202 offset:18432
    buffer_load_dwordx4 v211, s[16:19], s57 offen offset:1024 lds
    v_mfma_f32_16x16x32_bf16 v[24:27], v[60:63], a[152:155], v[24:27]
    v_mfma_f32_16x16x32_bf16 v[28:31], v[60:63], a[156:159], v[28:31]
    s_waitcnt vmcnt(15)
    s_barrier
    v_subrev_u32 v245, s36, v239
    v_cmp_le_u32 vcc, 4, v245
    v_cmp_ge_u32 s[64:65], 8, v245
    s_nop 1
    s_and_b32 s64, vcc_lo, s64
    s_and_b32 s64, s64, s60
    s_cmp_eq_u32 s64, s60
    s_cbranch_scc0 L_pathB
    s_mov_b64 vcc, 0
    s_waitcnt lgkmcnt(8)
    v_mfma_f32_16x16x32_bf16 v[16:19], v[64:67], v[140:143], v[16:19]
    ds_read_b64_tr_b16 v[52:53], v202 offset:20480
    v_mfma_f32_16x16x32_bf16 v[20:23], v[64:67], v[144:147], v[20:23]
    ds_read_b64_tr_b16 v[54:55], v202 offset:22528
    v_mfma_f32_16x16x32_bf16 v[24:27], v[64:67], v[148:151], v[24:27]
    v_mfma_f32_16x16x32_bf16 v[28:31], v[64:67], v[152:155], v[28:31]
    s_waitcnt lgkmcnt(8)
    v_mfma_f32_16x16x32_bf16 v[16:19], v[68:71], a[160:163], v[16:19]
    ds_read_b64_tr_b16 v[56:57], v214 offset:24576
    buffer_load_dwordx4 v[164:167], v240, s[20:23], s40 offen offset:0 sc1
    v_mfma_f32_16x16x32_bf16 v[20:23], v[68:71], a[164:167], v[20:23]
    ds_read_b64_tr_b16 v[58:59], v214 offset:32768
    v_mfma_f32_16x16x32_bf16 v[24:27], v[68:71], a[168:171], v[24:27]
    v_mfma_f32_16x16x32_bf16 v[28:31], v[68:71], a[172:175], v[28:31]
    buffer_load_dwordx4 v[168:171], v240, s[20:23], s40 offen offset:1024 sc1
    s_waitcnt lgkmcnt(8)
    v_mfma_f32_16x16x32_bf16 v[16:19], v[72:75], a[176:179], v[16:19]
    ds_read_b64_tr_b16 v[60:61], v217 offset:24576
    v_mfma_f32_16x16x32_bf16 v[20:23], v[72:75], a[180:183], v[20:23]
    ds_read_b64_tr_b16 v[62:63], v217 offset:32768
    v_mfma_f32_16x16x32_bf16 v[24:27], v[72:75], a[184:187], v[24:27]
    buffer_load_dwordx4 v[172:175], v240, s[20:23], s41 offen offset:0 sc1
    v_mfma_f32_16x16x32_bf16 v[28:31], v[72:75], a[188:191], v[28:31]
    s_waitcnt lgkmcnt(8)
    v_mfma_f32_16x16x32_bf16 v[16:19], v[76:79], a[192:195], v[16:19]
    ds_read_b64_tr_b16 v[64:65], v224 offset:24576
    v_mfma_f32_16x16x32_bf16 v[20:23], v[76:79], a[196:199], v[20:23]
    ds_read_b64_tr_b16 v[66:67], v224 offset:32768
    buffer_load_dwordx4 v[176:179], v240, s[20:23], s41 offen offset:1024 sc1
    v_mfma_f32_16x16x32_bf16 v[24:27], v[76:79], a[200:203], v[24:27]
    v_mfma_f32_16x16x32_bf16 v[28:31], v[76:79], a[204:207], v[28:31]
    s_waitcnt lgkmcnt(8)
    v_mfma_f32_16x16x32_bf16 v[16:19], v[48:51], a[208:211], v[16:19]
    ds_read_b64_tr_b16 v[68:69], v227 offset:24576
    buffer_load_dwordx4 v[180:183], v240, s[20:23], s42 offen offset:0 sc1
    v_mfma_f32_16x16x32_bf16 v[20:23], v[48:51], a[212:215], v[20:23]
    ds_read_b64_tr_b16 v[70:71], v227 offset:32768
    v_mfma_f32_16x16x32_bf16 v[24:27], v[48:51], a[216:219], v[24:27]
    v_mfma_f32_16x16x32_bf16 v[28:31], v[48:51], a[220:223], v[28:31]
    buffer_load_dwordx4 v[184:187], v240, s[20:23], s42 offen offset:1024 sc1
    s_waitcnt lgkmcnt(8)
    v_mfma_f32_16x16x32_bf16 v[16:19], v[52:55], a[224:227], v[16:19]
    ds_read_b64_tr_b16 v[72:73], v202 offset:40960
    v_mfma_f32_16x16x32_bf16 v[20:23], v[52:55], a[228:231], v[20:23]
    ds_read_b64_tr_b16 v[74:75], v202 offset:43008
    v_mfma_f32_16x16x32_bf16 v[24:27], v[52:55], a[232:235], v[24:27]
    v_mfma_f32_16x16x32_bf16 v[28:31], v[52:55], a[236:239], v[28:31]
    s_waitcnt vmcnt(14)
    s_barrier
    s_waitcnt lgkmcnt(8)
    v_mfma_f32_16x16x32_bf16 v[32:35], v[56:59], v[92:95], 0
    ds_read_b64_tr_b16 v[76:77], v202 offset:45056
    v_mfma_f32_16x16x32_bf16 v[36:39], v[56:59], v[96:99], 0
    ds_read_b64_tr_b16 v[78:79], v202 offset:47104
    v_mfma_f32_16x16x32_bf16 v[40:43], v[56:59], v[100:103], 0
    v_mfma_f32_16x16x32_bf16 v[44:47], v[56:59], v[104:107], 0
    s_lshl_b32 s37, s74, 9
    s_waitcnt lgkmcnt(8)
    v_mfma_f32_16x16x32_bf16 v[32:35], v[60:63], a[0:3], v[32:35]
    ds_read_b64_tr_b16 v[48:49], v214 offset:49152
    v_cvt_pk_bf16_f32 v84, v16, v17
    v_mfma_f32_16x16x32_bf16 v[36:39], v[60:63], a[4:7], v[36:39]
    ds_read_b64_tr_b16 v[50:51], v214 offset:57344
    v_cvt_pk_bf16_f32 v85, v18, v19
    v_mfma_f32_16x16x32_bf16 v[40:43], v[60:63], a[8:11], v[40:43]
    v_cvt_pk_bf16_f32 v86, v20, v21
    v_mfma_f32_16x16x32_bf16 v[44:47], v[60:63], a[12:15], v[44:47]
    v_cvt_pk_bf16_f32 v87, v22, v23
    s_waitcnt lgkmcnt(8)
    v_mfma_f32_16x16x32_bf16 v[32:35], v[64:67], a[16:19], v[32:35]
    ds_read_b64_tr_b16 v[52:53], v217 offset:49152
    buffer_store_dwordx4 v[84:87], v221, s[20:23], s37 offen offset:0 sc1
    v_mfma_f32_16x16x32_bf16 v[36:39], v[64:67], a[20:23], v[36:39]
L_pg18:
    s_cbranch_vccnz L_walk_done
    ds_read_b64_tr_b16 v[54:55], v217 offset:57344
    v_cvt_pk_bf16_f32 v88, v24, v25
    v_mfma_f32_16x16x32_bf16 v[40:43], v[64:67], a[24:27], v[40:43]
    v_cvt_pk_bf16_f32 v89, v26, v27
    v_mfma_f32_16x16x32_bf16 v[44:47], v[64:67], a[28:31], v[44:47]
    v_cvt_pk_bf16_f32 v90, v28, v29
    s_waitcnt lgkmcnt(8)
    v_mfma_f32_16x16x32_bf16 v[32:35], v[68:71], a[32:35], v[32:35]
L_pg19:
    s_cbranch_vccnz L_walk_done
    ds_read_b64_tr_b16 v[56:57], v224 offset:49152
    v_cvt_pk_bf16_f32 v91, v30, v31
    v_mfma_f32_16x16x32_bf16 v[36:39], v[68:71], a[36:39], v[36:39]
    ds_read_b64_tr_b16 v[58:59], v224 offset:57344
    buffer_store_dwordx4 v[88:91], v221, s[20:23], s37 offen offset:1024 sc1
    v_mfma_f32_16x16x32_bf16 v[40:43], v[68:71], a[40:43], v[40:43]
    v_mfma_f32_16x16x32_bf16 v[44:47], v[68:71], a[44:47], v[44:47]
L_pg20:
    s_cbranch_vccnz L_walk_done
    s_waitcnt lgkmcnt(8)
    v_mfma_f32_16x16x32_bf16 v[32:35], v[72:75], a[48:51], v[32:35]
    ds_read_b64_tr_b16 v[60:61], v227 offset:49152
    v_mfma_f32_16x16x32_bf16 v[36:39], v[72:75], a[52:55], v[36:39]
    ds_read_b64_tr_b16 v[62:63], v227 offset:57344
    buffer_load_dwordx2 v[188:189], v242, s[24:27], s75 offen
    v_mfma_f32_16x16x32_bf16 v[40:43], v[72:75], a[56:59], v[40:43]
    v_mfma_f32_16x16x32_bf16 v[44:47], v[72:75], a[60:63], v[44:47]
    s_waitcnt lgkmcnt(8)
    v_mfma_f32_16x16x32_bf16 v[32:35], v[76:79], a[64:67], v[32:35]
    ds_read_b64_tr_b16 v[64:65], v203 offset:0
    buffer_load_dwordx2 v[190:191], v242, s[24:27], s75 offen
    v_mfma_f32_16x16x32_bf16 v[36:39], v[76:79], a[68:71], v[36:39]
    ds_read_b64_tr_b16 v[66:67], v203 offset:2048
    v_mfma_f32_16x16x32_bf16 v[40:43], v[76:79], a[72:75], v[40:43]
    v_mfma_f32_16x16x32_bf16 v[44:47], v[76:79], a[76:79], v[44:47]
    s_waitcnt vmcnt(10)
    s_barrier
    s_waitcnt lgkmcnt(8)
    v_mfma_f32_16x16x32_bf16 v[32:35], v[48:51], v[116:119], v[32:35]
    ds_read_b64_tr_b16 v[68:69], v203 offset:4096
    v_mfma_f32_16x16x32_bf16 v[36:39], v[48:51], v[120:123], v[36:39]
    ds_read_b64_tr_b16 v[70:71], v203 offset:6144
    v_mfma_f32_16x16x32_bf16 v[40:43], v[48:51], v[124:127], v[40:43]
    v_mfma_f32_16x16x32_bf16 v[44:47], v[48:51], v[128:131], v[44:47]
    s_waitcnt lgkmcnt(8)
    v_mfma_f32_16x16x32_bf16 v[32:35], v[52:55], a[80:83], v[32:35]
    ds_read_b64_tr_b16 v[72:73], v215 offset:57344
    v_mfma_f32_16x16x32_bf16 v[36:39], v[52:55], a[84:87], v[36:39]
    ds_read_b64_tr_b16 v[74:75], v216 offset:0
    v_mfma_f32_16x16x32_bf16 v[40:43], v[52:55], a[88:91], v[40:43]
    v_mfma_f32_16x16x32_bf16 v[44:47], v[52:55], a[92:95], v[44:47]
    s_waitcnt lgkmcnt(8)
    v_mfma_f32_16x16x32_bf16 v[32:35], v[56:59], a[96:99], v[32:35]
    ds_read_b64_tr_b16 v[76:77], v222 offset:57344
    v_mfma_f32_16x16x32_bf16 v[36:39], v[56:59], a[100:103], v[36:39]
    ds_read_b64_tr_b16 v[78:79], v223 offset:0
    v_mfma_f32_16x16x32_bf16 v[40:43], v[56:59], a[104:107], v[40:43]
    v_mfma_f32_16x16x32_bf16 v[44:47], v[56:59], a[108:111], v[44:47]
    s_waitcnt lgkmcnt(8)
    v_mfma_f32_16x16x32_bf16 v[32:35], v[60:63], a[112:115], v[32:35]
    ds_read_b64_tr_b16 v[48:49], v225 offset:57344
    v_mfma_f32_16x16x32_bf16 v[36:39], v[60:63], a[116:119], v[36:39]
    ds_read_b64_tr_b16 v[50:51], v226 offset:0
    v_mfma_f32_16x16x32_bf16 v[40:43], v[60:63], a[120:123], v[40:43]
    v_mfma_f32_16x16x32_bf16 v[44:47], v[60:63], a[124:127], v[44:47]
    s_waitcnt lgkmcnt(8)
    v_mfma_f32_16x16x32_bf16 v[32:35], v[64:67], a[128:131], v[32:35]
    ds_read_b64_tr_b16 v[52:53], v246 offset:57344
    v_mfma_f32_16x16x32_bf16 v[36:39], v[64:67], a[132:135], v[36:39]
    ds_read_b64_tr_b16 v[54:55], v247 offset:0
    v_mfma_f32_16x16x32_bf16 v[40:43], v[64:67], a[136:139], v[40:43]
    v_mfma_f32_16x16x32_bf16 v[44:47], v[64:67], a[140:143], v[44:47]
    s_waitcnt lgkmcnt(8)
    v_mfma_f32_16x16x32_bf16 v[32:35], v[68:71], a[144:147], v[32:35]
    ds_read_b64_tr_b16 v[56:57], v204 offset:8192
    v_mfma_f32_16x16x32_bf16 v[36:39], v[68:71], a[148:151], v[36:39]
    ds_read_b64_tr_b16 v[58:59], v204 offset:10240
    v_mfma_f32_16x16x32_bf16 v[40:43], v[68:71], a[152:155], v[40:43]
    v_mfma_f32_16x16x32_bf16 v[44:47], v[68:71], a[156:159], v[44:47]
    s_barrier
    s_waitcnt lgkmcnt(8)
    v_mfma_f32_16x16x32_bf16 v[32:35], v[72:75], v[140:143], v[32:35]
    ds_read_b64_tr_b16 v[60:61], v204 offset:12288
    v_mfma_f32_16x16x32_bf16 v[36:39], v[72:75], v[144:147], v[36:39]
    ds_read_b64_tr_b16 v[62:63], v204 offset:14336
    v_mfma_f32_16x16x32_bf16 v[40:43], v[72:75], v[148:151], v[40:43]
    v_mfma_f32_16x16x32_bf16 v[44:47], v[72:75], v[152:155], v[44:47]
    s_waitcnt lgkmcnt(8)
    v_mfma_f32_16x16x32_bf16 v[32:35], v[76:79], a[160:163], v[32:35]
    v_mfma_f32_16x16x32_bf16 v[36:39], v[76:79], a[164:167], v[36:39]
    v_mfma_f32_16x16x32_bf16 v[40:43], v[76:79], a[168:171], v[40:43]
    v_mfma_f32_16x16x32_bf16 v[44:47], v[76:79], a[172:175], v[44:47]
    s_waitcnt lgkmcnt(6)
    v_mfma_f32_16x16x32_bf16 v[32:35], v[48:51], a[176:179], v[32:35]
    v_mfma_f32_16x16x32_bf16 v[36:39], v[48:51], a[180:183], v[36:39]
    v_mfma_f32_16x16x32_bf16 v[40:43], v[48:51], a[184:187], v[40:43]
    v_mfma_f32_16x16x32_bf16 v[44:47], v[48:51], a[188:191], v[44:47]
    s_waitcnt lgkmcnt(4)
    v_mfma_f32_16x16x32_bf16 v[32:35], v[52:55], a[192:195], v[32:35]
    v_mfma_f32_16x16x32_bf16 v[36:39], v[52:55], a[196:199], v[36:39]
    v_mfma_f32_16x16x32_bf16 v[40:43], v[52:55], a[200:203], v[40:43]
    v_mfma_f32_16x16x32_bf16 v[44:47], v[52:55], a[204:207], v[44:47]
    s_waitcnt lgkmcnt(2)
    v_mfma_f32_16x16x32_bf16 v[32:35], v[56:59], a[208:211], v[32:35]
    v_mfma_f32_16x16x32_bf16 v[36:39], v[56:59], a[212:215], v[36:39]
    v_mfma_f32_16x16x32_bf16 v[40:43], v[56:59], a[216:219], v[40:43]
    v_mfma_f32_16x16x32_bf16 v[44:47], v[56:59], a[220:223], v[44:47]
    s_waitcnt lgkmcnt(0)
    v_mfma_f32_16x16x32_bf16 v[32:35], v[60:63], a[224:227], v[32:35]
    v_mfma_f32_16x16x32_bf16 v[36:39], v[60:63], a[228:231], v[36:39]
    v_mfma_f32_16x16x32_bf16 v[40:43], v[60:63], a[232:235], v[40:43]
    v_mfma_f32_16x16x32_bf16 v[44:47], v[60:63], a[236:239], v[44:47]
    s_waitcnt vmcnt(2)
    s_barrier
    s_add_u32 s62, s36, 8
    v_mov_b32 v237, s62
    s_cmp_lg_u32 s30, 0
    s_cbranch_scc1 L_np1A
    buffer_load_dword v239, v238, s[20:23], 0 offen sc1
    buffer_store_dword v237, v236, s[20:23], 0 offen sc1
    s_waitcnt vmcnt(1)
    v_subrev_u32 v245, s36, v239
    v_cmp_le_u32 vcc, 6, v245
    v_cmp_ge_u32 s[64:65], 8, v245
    s_nop 1
    s_and_b32 s64, vcc_lo, s64
    s_and_b32 s64, s64, s58
    s_cmp_eq_u32 s64, s58
    s_cbranch_scc1 L_early2_ok
    s_mov_b32 s62, 200000
L_early2_loop:
    buffer_load_dword v239, v238, s[20:23], 0 offen sc1
    s_waitcnt vmcnt(0)
    v_subrev_u32 v245, s36, v239
    v_cmp_le_u32 vcc, 6, v245
    v_cmp_ge_u32 s[64:65], 8, v245
    s_nop 1
    s_and_b32 s64, vcc_lo, s64
    s_and_b32 s64, s64, s58
    s_cmp_eq_u32 s64, s58
    s_cbranch_scc1 L_early2_ok
    s_sub_u32 s62, s62, 1
    s_cmp_lg_u32 s62, 0
    s_cbranch_scc1 L_early2_loop
L_early2_ok:
    s_mov_b64 vcc, 0
L_np1A:
    s_barrier
    buffer_load_dwordx4 a[72:75], v240, s[20:23], s43 offen offset:0 sc1
    buffer_load_dwordx4 a[76:79], v240, s[20:23], s43 offen offset:1024 sc1
    buffer_load_dwordx4 a[80:83], v240, s[20:23], s44 offen offset:0 sc1
    buffer_load_dwordx4 a[84:87], v240, s[20:23], s44 offen offset:1024 sc1
    s_cmp_lt_u32 s29, 4
    s_cselect_b32 s37, 1, 0
    s_cmp_eq_u32 s30, 3
    s_cselect_b32 s37, s37, 0
    s_cmp_eq_u32 s37, 0
    s_cbranch_scc1 L_no8aA
    v_and_b32 v2, 63, v0
    v_lshlrev_b32 v8, 4, v2
    s_lshl_b32 s93, s29, 11
    v_add_u32 v8, s93, v8
    s_mov_b32 s94, 524288
    buffer_load_dwordx4 a[0:3], v8, s[20:23], s94 offen offset:0 sc1
    buffer_load_dwordx4 a[4:7], v8, s[20:23], s94 offen offset:1024 sc1
    s_mov_b32 s94, 532480
    buffer_load_dwordx4 a[8:11], v8, s[20:23], s94 offen offset:0 sc1
    buffer_load_dwordx4 a[12:15], v8, s[20:23], s94 offen offset:1024 sc1
    s_mov_b32 s94, 540672
    buffer_load_dwordx4 a[16:19], v8, s[20:23], s94 offen offset:0 sc1
    buffer_load_dwordx4 a[20:23], v8, s[20:23], s94 offen offset:1024 sc1
    s_mov_b32 s94, 548864
    buffer_load_dwordx4 a[24:27], v8, s[20:23], s94 offen offset:0 sc1
    buffer_load_dwordx4 a[28:31], v8, s[20:23], s94 offen offset:1024 sc1
    s_mov_b32 s94, 557056
    buffer_load_dwordx4 a[32:35], v8, s[20:23], s94 offen offset:0 sc1
    buffer_load_dwordx4 a[36:39], v8, s[20:23], s94 offen offset:1024 sc1
    s_mov_b32 s94, 565248
    buffer_load_dwordx4 a[40:43], v8, s[20:23], s94 offen offset:0 sc1
    buffer_load_dwordx4 a[44:47], v8, s[20:23], s94 offen offset:1024 sc1
    s_mov_b32 s94, 573440
    buffer_load_dwordx4 a[48:51], v8, s[20:23], s94 offen offset:0 sc1
    buffer_load_dwordx4 a[52:55], v8, s[20:23], s94 offen offset:1024 sc1
    s_mov_b32 s94, 581632
    buffer_load_dwordx4 a[56:59], v8, s[20:23], s94 offen offset:0 sc1
    buffer_load_dwordx4 a[60:63], v8, s[20:23], s94 offen offset:1024 sc1
    v_lshrrev_b32 v5, 4, v2
    v_and_b32 v6, 15, v2
    s_lshl_b32 s93, s29, 5
    s_add_u32 s93, s93, 1024
    v_lshlrev_b32 v9, 3, v5
    v_add_u32 v9, s93, v9
    buffer_load_dwordx2 a[64:65], v9, s[24:27], 0 offen
    buffer_load_dwordx2 a[66:67], v9, s[24:27], 0 offen
    v_and_b32 v14, 1, v5
    v_lshl_add_u32 v10, v14, 4, v6
    v_mul_u32_u24 v10, 1152, v10
    v_lshrrev_b32 v15, 1, v5
    v_lshl_add_u32 v10, v15, 4, v10
    v_add_u32 v10, s93, v10
L_no8aA:
    s_cmp_lg_u32 s30, 0
    s_cbranch_scc1 L_np2A
    v_subrev_u32 v245, s36, v239
    v_cmp_le_u32 vcc, 8, v245
    v_cmp_ge_u32 s[64:65], 8, v245
    s_nop 1
    s_and_b32 s64, vcc_lo, s64
    s_and_b32 s64, s64, s59
    s_cmp_eq_u32 s64, s59
    s_cbranch_scc1 L_late3_ok
    s_mov_b32 s62, 200000
L_late3_loop:
    buffer_load_dword v239, v238, s[20:23], 0 offen sc1
    s_waitcnt vmcnt(0)
    v_subrev_u32 v245, s36, v239
    v_cmp_le_u32 vcc, 8, v245
    v_cmp_ge_u32 s[64:65], 8, v245
    s_nop 1
    s_and_b32 s64, vcc_lo, s64
    s_and_b32 s64, s64, s59
    s_cmp_eq_u32 s64, s59
    s_cbranch_scc1 L_late3_ok
    s_sub_u32 s62, s62, 1
    s_cmp_lg_u32 s62, 0
    s_cbranch_scc1 L_late3_loop
L_late3_ok:
    s_mov_b64 vcc, 0
L_np2A:
    s_barrier
    buffer_load_dwordx4 a[88:91], v240, s[20:23], s45 offen offset:0 sc1
    buffer_load_dwordx4 a[92:95], v240, s[20:23], s45 offen offset:1024 sc1
    buffer_load_dwordx4 a[96:99], v240, s[20:23], s46 offen offset:0 sc1
    buffer_load_dwordx4 a[100:103], v240, s[20:23], s46 offen offset:1024 sc1
    s_waitcnt vmcnt(4)
    v_mfma_f32_16x16x32_bf16 v[32:35], v[228:231], v[188:191], v[32:35]
    v_mfma_f32_16x16x32_bf16 v[36:39], v[232:235], v[188:191], v[36:39]
    v_mfma_f32_16x16x32_bf16 v[40:43], v[228:231], v[188:191], v[40:43]
    v_mfma_f32_16x16x32_bf16 v[44:47], v[232:235], v[188:191], v[44:47]
    v_mfma_f32_16x16x32_bf16 v[32:35], v[228:231], v[164:167], v[32:35]
    v_mfma_f32_16x16x32_bf16 v[36:39], v[232:235], v[164:167], v[36:39]
    v_mfma_f32_16x16x32_bf16 v[40:43], v[228:231], v[168:171], v[40:43]
    v_mfma_f32_16x16x32_bf16 v[44:47], v[232:235], v[168:171], v[44:47]
    v_mfma_f32_16x16x32_bf16 v[32:35], v[228:231], v[172:175], v[32:35]
    v_mfma_f32_16x16x32_bf16 v[36:39], v[232:235], v[172:175], v[36:39]
    v_mfma_f32_16x16x32_bf16 v[40:43], v[228:231], v[176:179], v[40:43]
    v_mfma_f32_16x16x32_bf16 v[44:47], v[232:235], v[176:179], v[44:47]
    v_mfma_f32_16x16x32_bf16 v[32:35], v[228:231], v[180:183], v[32:35]
    v_mfma_f32_16x16x32_bf16 v[36:39], v[232:235], v[180:183], v[36:39]
    v_mfma_f32_16x16x32_bf16 v[40:43], v[228:231], v[184:187], v[40:43]
    v_mfma_f32_16x16x32_bf16 v[44:47], v[232:235], v[184:187], v[44:47]
    v_mfma_f32_16x16x32_bf16 v[32:35], v[228:231], a[72:75], v[32:35]
    v_mfma_f32_16x16x32_bf16 v[36:39], v[232:235], a[72:75], v[36:39]
    v_mfma_f32_16x16x32_bf16 v[40:43], v[228:231], a[76:79], v[40:43]
    v_mfma_f32_16x16x32_bf16 v[44:47], v[232:235], a[76:79], v[44:47]
    v_mfma_f32_16x16x32_bf16 v[32:35], v[228:231], a[80:83], v[32:35]
    v_mfma_f32_16x16x32_bf16 v[36:39], v[232:235], a[80:83], v[36:39]
    v_mfma_f32_16x16x32_bf16 v[40:43], v[228:231], a[84:87], v[40:43]
    v_mfma_f32_16x16x32_bf16 v[44:47], v[232:235], a[84:87], v[44:47]
    s_cmp_eq_u32 s37, 0
    s_cbranch_scc1 L_no8bA
    v_mfma_f32_16x16x32_bf16 v[16:19], v[228:231], a[64:67], 0
    v_mfma_f32_16x16x32_bf16 v[20:23], v[232:235], a[64:67], 0
    v_mfma_f32_16x16x32_bf16 v[24:27], v[228:231], a[64:67], 0
    v_mfma_f32_16x16x32_bf16 v[28:31], v[232:235], a[64:67], 0
    v_mfma_f32_16x16x32_bf16 v[16:19], v[228:231], a[0:3], v[16:19]
    v_mfma_f32_16x16x32_bf16 v[20:23], v[232:235], a[0:3], v[20:23]
    v_mfma_f32_16x16x32_bf16 v[24:27], v[228:231], a[4:7], v[24:27]
    v_mfma_f32_16x16x32_bf16 v[28:31], v[232:235], a[4:7], v[28:31]
    v_mfma_f32_16x16x32_bf16 v[16:19], v[228:231], a[8:11], v[16:19]
    v_mfma_f32_16x16x32_bf16 v[20:23], v[232:235], a[8:11], v[20:23]
    v_mfma_f32_16x16x32_bf16 v[24:27], v[228:231], a[12:15], v[24:27]
    v_mfma_f32_16x16x32_bf16 v[28:31], v[232:235], a[12:15], v[28:31]
    v_mfma_f32_16x16x32_bf16 v[16:19], v[228:231], a[16:19], v[16:19]
    v_mfma_f32_16x16x32_bf16 v[20:23], v[232:235], a[16:19], v[20:23]
    v_mfma_f32_16x16x32_bf16 v[24:27], v[228:231], a[20:23], v[24:27]
    v_mfma_f32_16x16x32_bf16 v[28:31], v[232:235], a[20:23], v[28:31]
    v_mfma_f32_16x16x32_bf16 v[16:19], v[228:231], a[24:27], v[16:19]
    v_mfma_f32_16x16x32_bf16 v[20:23], v[232:235], a[24:27], v[20:23]
    v_mfma_f32_16x16x32_bf16 v[24:27], v[228:231], a[28:31], v[24:27]
    v_mfma_f32_16x16x32_bf16 v[28:31], v[232:235], a[28:31], v[28:31]
    v_mfma_f32_16x16x32_bf16 v[16:19], v[228:231], a[32:35], v[16:19]
    v_mfma_f32_16x16x32_bf16 v[20:23], v[232:235], a[32:35], v[20:23]
    v_mfma_f32_16x16x32_bf16 v[24:27], v[228:231], a[36:39], v[24:27]
    v_mfma_f32_16x16x32_bf16 v[28:31], v[232:235], a[36:39], v[28:31]
    v_mfma_f32_16x16x32_bf16 v[16:19], v[228:231], a[40:43], v[16:19]
    v_mfma_f32_16x16x32_bf16 v[20:23], v[232:235], a[40:43], v[20:23]
    v_mfma_f32_16x16x32_bf16 v[24:27], v[228:231], a[44:47], v[24:27]
    v_mfma_f32_16x16x32_bf16 v[28:31], v[232:235], a[44:47], v[28:31]
    v_mfma_f32_16x16x32_bf16 v[16:19], v[228:231], a[48:51], v[16:19]
    v_mfma_f32_16x16x32_bf16 v[20:23], v[232:235], a[48:51], v[20:23]
    v_mfma_f32_16x16x32_bf16 v[24:27], v[228:231], a[52:55], v[24:27]
    v_mfma_f32_16x16x32_bf16 v[28:31], v[232:235], a[52:55], v[28:31]
    v_mfma_f32_16x16x32_bf16 v[16:19], v[228:231], a[56:59], v[16:19]
    v_mfma_f32_16x16x32_bf16 v[20:23], v[232:235], a[56:59], v[20:23]
    v_mfma_f32_16x16x32_bf16 v[24:27], v[228:231], a[60:63], v[24:27]
    v_mfma_f32_16x16x32_bf16 v[28:31], v[232:235], a[60:63], v[28:31]
    s_nop 7
    s_nop 0
    v_cvt_pk_bf16_f32 v84, v16, v17
    v_cvt_pk_bf16_f32 v85, v18, v19
    v_cvt_pk_bf16_f32 v86, v20, v21
    v_cvt_pk_bf16_f32 v87, v22, v23
    v_cvt_pk_bf16_f32 v88, v24, v25
    v_cvt_pk_bf16_f32 v89, v26, v27
    v_cvt_pk_bf16_f32 v90, v28, v29
    v_cvt_pk_bf16_f32 v91, v30, v31
    v_add_u32 v11, 36864, v10
    s_nop 0
    v_permlane16_swap_b32 v84, v86
    v_permlane16_swap_b32 v85, v87
    v_permlane16_swap_b32 v88, v90
    v_permlane16_swap_b32 v89, v91
    buffer_store_dwordx4 v[84:87], v10, s[8:11], 0 offen
    buffer_store_dwordx4 v[88:91], v11, s[8:11], 0 offen
L_no8bA:
    s_waitcnt vmcnt(0)
    v_mfma_f32_16x16x32_bf16 v[32:35], v[228:231], a[88:91], v[32:35]
    v_mfma_f32_16x16x32_bf16 v[36:39], v[232:235], a[88:91], v[36:39]
    v_mfma_f32_16x16x32_bf16 v[40:43], v[228:231], a[92:95], v[40:43]
    v_mfma_f32_16x16x32_bf16 v[44:47], v[232:235], a[92:95], v[44:47]
    v_mfma_f32_16x16x32_bf16 v[32:35], v[228:231], a[96:99], v[32:35]
    v_mfma_f32_16x16x32_bf16 v[36:39], v[232:235], a[96:99], v[36:39]
    v_mfma_f32_16x16x32_bf16 v[40:43], v[228:231], a[100:103], v[40:43]
    v_mfma_f32_16x16x32_bf16 v[44:47], v[232:235], a[100:103], v[44:47]
    s_nop 7
    s_nop 0
    v_cvt_pk_bf16_f32 v84, v32, v33
    v_cvt_pk_bf16_f32 v85, v34, v35
    v_cvt_pk_bf16_f32 v86, v36, v37
    v_cvt_pk_bf16_f32 v87, v38, v39
    v_cvt_pk_bf16_f32 v88, v40, v41
    v_cvt_pk_bf16_f32 v89, v42, v43
    v_cvt_pk_bf16_f32 v90, v44, v45
    v_cvt_pk_bf16_f32 v91, v46, v47
    v_add_u32 v11, 36864, v241
    s_nop 0
    v_permlane16_swap_b32 v84, v86
    v_permlane16_swap_b32 v85, v87
    v_permlane16_swap_b32 v88, v90
    v_permlane16_swap_b32 v89, v91
    buffer_store_dwordx4 v[84:87], v241, s[8:11], s75 offen
    buffer_store_dwordx4 v[88:91], v11, s[8:11], s75 offen
    s_branch L_tail_done
L_pathB:
    s_mov_b64 vcc, 0
    s_waitcnt lgkmcnt(8)
    v_mfma_f32_16x16x32_bf16 v[16:19], v[64:67], v[140:143], v[16:19]
    ds_read_b64_tr_b16 v[52:53], v202 offset:20480
    v_mfma_f32_16x16x32_bf16 v[20:23], v[64:67], v[144:147], v[20:23]
    ds_read_b64_tr_b16 v[54:55], v202 offset:22528
    v_mfma_f32_16x16x32_bf16 v[24:27], v[64:67], v[148:151], v[24:27]
    v_mfma_f32_16x16x32_bf16 v[28:31], v[64:67], v[152:155], v[28:31]
    s_waitcnt lgkmcnt(8)
    v_mfma_f32_16x16x32_bf16 v[16:19], v[68:71], a[160:163], v[16:19]
    ds_read_b64_tr_b16 v[56:57], v214 offset:24576
    v_mfma_f32_16x16x32_bf16 v[20:23], v[68:71], a[164:167], v[20:23]
    ds_read_b64_tr_b16 v[58:59], v214 offset:32768
    v_mfma_f32_16x16x32_bf16 v[24:27], v[68:71], a[168:171], v[24:27]
    v_mfma_f32_16x16x32_bf16 v[28:31], v[68:71], a[172:175], v[28:31]
    s_waitcnt lgkmcnt(8)
    v_mfma_f32_16x16x32_bf16 v[16:19], v[72:75], a[176:179], v[16:19]
    ds_read_b64_tr_b16 v[60:61], v217 offset:24576
    v_mfma_f32_16x16x32_bf16 v[20:23], v[72:75], a[180:183], v[20:23]
    ds_read_b64_tr_b16 v[62:63], v217 offset:32768
    v_mfma_f32_16x16x32_bf16 v[24:27], v[72:75], a[184:187], v[24:27]
    v_mfma_f32_16x16x32_bf16 v[28:31], v[72:75], a[188:191], v[28:31]
    s_waitcnt lgkmcnt(8)
    v_mfma_f32_16x16x32_bf16 v[16:19], v[76:79], a[192:195], v[16:19]
    ds_read_b64_tr_b16 v[64:65], v224 offset:24576
    v_mfma_f32_16x16x32_bf16 v[20:23], v[76:79], a[196:199], v[20:23]
    ds_read_b64_tr_b16 v[66:67], v224 offset:32768
    v_mfma_f32_16x16x32_bf16 v[24:27], v[76:79], a[200:203], v[24:27]
    v_mfma_f32_16x16x32_bf16 v[28:31], v[76:79], a[204:207], v[28:31]
    s_waitcnt lgkmcnt(8)
    v_mfma_f32_16x16x32_bf16 v[16:19], v[48:51], a[208:211], v[16:19]
    ds_read_b64_tr_b16 v[68:69], v227 offset:24576
    v_mfma_f32_16x16x32_bf16 v[20:23], v[48:51], a[212:215], v[20:23]
    ds_read_b64_tr_b16 v[70:71], v227 offset:32768
    v_mfma_f32_16x16x32_bf16 v[24:27], v[48:51], a[216:219], v[24:27]
    v_mfma_f32_16x16x32_bf16 v[28:31], v[48:51], a[220:223], v[28:31]
    s_waitcnt lgkmcnt(8)
    v_mfma_f32_16x16x32_bf16 v[16:19], v[52:55], a[224:227], v[16:19]
    ds_read_b64_tr_b16 v[72:73], v202 offset:40960
    v_mfma_f32_16x16x32_bf16 v[20:23], v[52:55], a[228:231], v[20:23]
    ds_read_b64_tr_b16 v[74:75], v202 offset:43008
    v_mfma_f32_16x16x32_bf16 v[24:27], v[52:55], a[232:235], v[24:27]
    v_mfma_f32_16x16x32_bf16 v[28:31], v[52:55], a[236:239], v[28:31]
    s_waitcnt vmcnt(8)
    s_barrier
    s_waitcnt lgkmcnt(8)
    v_mfma_f32_16x16x32_bf16 v[32:35], v[56:59], v[92:95], 0
    ds_read_b64_tr_b16 v[76:77], v202 offset:45056
    v_mfma_f32_16x16x32_bf16 v[36:39], v[56:59], v[96:99], 0
    ds_read_b64_tr_b16 v[78:79], v202 offset:47104
    v_mfma_f32_16x16x32_bf16 v[40:43], v[56:59], v[100:103], 0
    v_mfma_f32_16x16x32_bf16 v[44:47], v[56:59], v[104:107], 0
    s_lshl_b32 s37, s74, 9
    s_waitcnt lgkmcnt(8)
    v_mfma_f32_16x16x32_bf16 v[32:35], v[60:63], a[0:3], v[32:35]
    ds_read_b64_tr_b16 v[48:49], v214 offset:49152
    v_cvt_pk_bf16_f32 v84, v16, v17
    v_mfma_f32_16x16x32_bf16 v[36:39], v[60:63], a[4:7], v[36:39]
    ds_read_b64_tr_b16 v[50:51], v214 offset:57344
    v_cvt_pk_bf16_f32 v85, v18, v19
    v_mfma_f32_16x16x32_bf16 v[40:43], v[60:63], a[8:11], v[40:43]
    v_cvt_pk_bf16_f32 v86, v20, v21
    v_mfma_f32_16x16x32_bf16 v[44:47], v[60:63], a[12:15], v[44:47]
    v_cvt_pk_bf16_f32 v87, v22, v23
    s_waitcnt lgkmcnt(8)
    v_mfma_f32_16x16x32_bf16 v[32:35], v[64:67], a[16:19], v[32:35]
    ds_read_b64_tr_b16 v[52:53], v217 offset:49152
    buffer_store_dwordx4 v[84:87], v221, s[20:23], s37 offen offset:0 sc1
    v_mfma_f32_16x16x32_bf16 v[36:39], v[64:67], a[20:23], v[36:39]
    ds_read_b64_tr_b16 v[54:55], v217 offset:57344
    v_cvt_pk_bf16_f32 v88, v24, v25
    v_mfma_f32_16x16x32_bf16 v[40:43], v[64:67], a[24:27], v[40:43]
    v_cvt_pk_bf16_f32 v89, v26, v27
    v_mfma_f32_16x16x32_bf16 v[44:47], v[64:67], a[28:31], v[44:47]
    v_cvt_pk_bf16_f32 v90, v28, v29
    s_waitcnt lgkmcnt(8)
    v_mfma_f32_16x16x32_bf16 v[32:35], v[68:71], a[32:35], v[32:35]
    ds_read_b64_tr_b16 v[56:57], v224 offset:49152
    v_cvt_pk_bf16_f32 v91, v30, v31
    v_mfma_f32_16x16x32_bf16 v[36:39], v[68:71], a[36:39], v[36:39]
    ds_read_b64_tr_b16 v[58:59], v224 offset:57344
    buffer_store_dwordx4 v[88:91], v221, s[20:23], s37 offen offset:1024 sc1
    v_mfma_f32_16x16x32_bf16 v[40:43], v[68:71], a[40:43], v[40:43]
    v_mfma_f32_16x16x32_bf16 v[44:47], v[68:71], a[44:47], v[44:47]
    s_waitcnt lgkmcnt(8)
    v_mfma_f32_16x16x32_bf16 v[32:35], v[72:75], a[48:51], v[32:35]
    ds_read_b64_tr_b16 v[60:61], v227 offset:49152
    v_mfma_f32_16x16x32_bf16 v[36:39], v[72:75], a[52:55], v[36:39]
    ds_read_b64_tr_b16 v[62:63], v227 offset:57344
    buffer_load_dwordx2 v[188:189], v242, s[24:27], s75 offen
    v_mfma_f32_16x16x32_bf16 v[40:43], v[72:75], a[56:59], v[40:43]
    v_mfma_f32_16x16x32_bf16 v[44:47], v[72:75], a[60:63], v[44:47]
    s_waitcnt lgkmcnt(8)
    v_mfma_f32_16x16x32_bf16 v[32:35], v[76:79], a[64:67], v[32:35]
    ds_read_b64_tr_b16 v[64:65], v203 offset:0
    buffer_load_dwordx2 v[190:191], v242, s[24:27], s75 offen
    v_mfma_f32_16x16x32_bf16 v[36:39], v[76:79], a[68:71], v[36:39]
    ds_read_b64_tr_b16 v[66:67], v203 offset:2048
    v_mfma_f32_16x16x32_bf16 v[40:43], v[76:79], a[72:75], v[40:43]
    v_mfma_f32_16x16x32_bf16 v[44:47], v[76:79], a[76:79], v[44:47]
    s_waitcnt vmcnt(4)
    s_barrier
    s_waitcnt lgkmcnt(8)
    v_mfma_f32_16x16x32_bf16 v[32:35], v[48:51], v[116:119], v[32:35]
    ds_read_b64_tr_b16 v[68:69], v203 offset:4096
    v_mfma_f32_16x16x32_bf16 v[36:39], v[48:51], v[120:123], v[36:39]
    ds_read_b64_tr_b16 v[70:71], v203 offset:6144
    v_mfma_f32_16x16x32_bf16 v[40:43], v[48:51], v[124:127], v[40:43]
    v_mfma_f32_16x16x32_bf16 v[44:47], v[48:51], v[128:131], v[44:47]
    s_waitcnt lgkmcnt(8)
    v_mfma_f32_16x16x32_bf16 v[32:35], v[52:55], a[80:83], v[32:35]
    ds_read_b64_tr_b16 v[72:73], v215 offset:57344
    v_mfma_f32_16x16x32_bf16 v[36:39], v[52:55], a[84:87], v[36:39]
    ds_read_b64_tr_b16 v[74:75], v216 offset:0
    v_mfma_f32_16x16x32_bf16 v[40:43], v[52:55], a[88:91], v[40:43]
    v_mfma_f32_16x16x32_bf16 v[44:47], v[52:55], a[92:95], v[44:47]
    s_waitcnt lgkmcnt(8)
    v_mfma_f32_16x16x32_bf16 v[32:35], v[56:59], a[96:99], v[32:35]
    ds_read_b64_tr_b16 v[76:77], v222 offset:57344
    v_mfma_f32_16x16x32_bf16 v[36:39], v[56:59], a[100:103], v[36:39]
    ds_read_b64_tr_b16 v[78:79], v223 offset:0
    v_mfma_f32_16x16x32_bf16 v[40:43], v[56:59], a[104:107], v[40:43]
    v_mfma_f32_16x16x32_bf16 v[44:47], v[56:59], a[108:111], v[44:47]
    s_waitcnt lgkmcnt(8)
    v_mfma_f32_16x16x32_bf16 v[32:35], v[60:63], a[112:115], v[32:35]
    ds_read_b64_tr_b16 v[48:49], v225 offset:57344
    v_mfma_f32_16x16x32_bf16 v[36:39], v[60:63], a[116:119], v[36:39]
    ds_read_b64_tr_b16 v[50:51], v226 offset:0
    v_mfma_f32_16x16x32_bf16 v[40:43], v[60:63], a[120:123], v[40:43]
    v_mfma_f32_16x16x32_bf16 v[44:47], v[60:63], a[124:127], v[44:47]
    s_waitcnt lgkmcnt(8)
    v_mfma_f32_16x16x32_bf16 v[32:35], v[64:67], a[128:131], v[32:35]
    ds_read_b64_tr_b16 v[52:53], v246 offset:57344
    v_mfma_f32_16x16x32_bf16 v[36:39], v[64:67], a[132:135], v[36:39]
    ds_read_b64_tr_b16 v[54:55], v247 offset:0
    v_mfma_f32_16x16x32_bf16 v[40:43], v[64:67], a[136:139], v[40:43]
    v_mfma_f32_16x16x32_bf16 v[44:47], v[64:67], a[140:143], v[44:47]
    s_waitcnt lgkmcnt(8)
    v_mfma_f32_16x16x32_bf16 v[32:35], v[68:71], a[144:147], v[32:35]
    ds_read_b64_tr_b16 v[56:57], v204 offset:8192
    v_mfma_f32_16x16x32_bf16 v[36:39], v[68:71], a[148:151], v[36:39]
    ds_read_b64_tr_b16 v[58:59], v204 offset:10240
    v_mfma_f32_16x16x32_bf16 v[40:43], v[68:71], a[152:155], v[40:43]
    v_mfma_f32_16x16x32_bf16 v[44:47], v[68:71], a[156:159], v[44:47]
    s_barrier
    s_waitcnt lgkmcnt(8)
    v_mfma_f32_16x16x32_bf16 v[32:35], v[72:75], v[140:143], v[32:35]
    ds_read_b64_tr_b16 v[60:61], v204 offset:12288
    v_mfma_f32_16x16x32_bf16 v[36:39], v[72:75], v[144:147], v[36:39]
    ds_read_b64_tr_b16 v[62:63], v204 offset:14336
    v_mfma_f32_16x16x32_bf16 v[40:43], v[72:75], v[148:151], v[40:43]
    v_mfma_f32_16x16x32_bf16 v[44:47], v[72:75], v[152:155], v[44:47]
    s_waitcnt lgkmcnt(8)
    v_mfma_f32_16x16x32_bf16 v[32:35], v[76:79], a[160:163], v[32:35]
    v_mfma_f32_16x16x32_bf16 v[36:39], v[76:79], a[164:167], v[36:39]
    v_mfma_f32_16x16x32_bf16 v[40:43], v[76:79], a[168:171], v[40:43]
    v_mfma_f32_16x16x32_bf16 v[44:47], v[76:79], a[172:175], v[44:47]
    s_waitcnt lgkmcnt(6)
    v_mfma_f32_16x16x32_bf16 v[32:35], v[48:51], a[176:179], v[32:35]
    v_mfma_f32_16x16x32_bf16 v[36:39], v[48:51], a[180:183], v[36:39]
    v_mfma_f32_16x16x32_bf16 v[40:43], v[48:51], a[184:187], v[40:43]
    v_mfma_f32_16x16x32_bf16 v[44:47], v[48:51], a[188:191], v[44:47]
    s_waitcnt lgkmcnt(4)
    v_mfma_f32_16x16x32_bf16 v[32:35], v[52:55], a[192:195], v[32:35]
    v_mfma_f32_16x16x32_bf16 v[36:39], v[52:55], a[196:199], v[36:39]
    v_mfma_f32_16x16x32_bf16 v[40:43], v[52:55], a[200:203], v[40:43]
    v_mfma_f32_16x16x32_bf16 v[44:47], v[52:55], a[204:207], v[44:47]
    s_waitcnt lgkmcnt(2)
    v_mfma_f32_16x16x32_bf16 v[32:35], v[56:59], a[208:211], v[32:35]
    v_mfma_f32_16x16x32_bf16 v[36:39], v[56:59], a[212:215], v[36:39]
    v_mfma_f32_16x16x32_bf16 v[40:43], v[56:59], a[216:219], v[40:43]
    v_mfma_f32_16x16x32_bf16 v[44:47], v[56:59], a[220:223], v[44:47]
    s_waitcnt lgkmcnt(0)
    v_mfma_f32_16x16x32_bf16 v[32:35], v[60:63], a[224:227], v[32:35]
    v_mfma_f32_16x16x32_bf16 v[36:39], v[60:63], a[228:231], v[36:39]
    v_mfma_f32_16x16x32_bf16 v[40:43], v[60:63], a[232:235], v[40:43]
    v_mfma_f32_16x16x32_bf16 v[44:47], v[60:63], a[236:239], v[44:47]
    s_waitcnt vmcnt(2)
    s_barrier
    s_add_u32 s62, s36, 8
    v_mov_b32 v237, s62
    s_cmp_lg_u32 s30, 0
    s_cbranch_scc1 L_np1B
    buffer_load_dword v239, v238, s[20:23], 0 offen sc1
    buffer_store_dword v237, v236, s[20:23], 0 offen sc1
    s_waitcnt vmcnt(1)
    v_subrev_u32 v245, s36, v239
    v_cmp_le_u32 vcc, 6, v245
    v_cmp_ge_u32 s[64:65], 8, v245
    s_nop 1
    s_and_b32 s64, vcc_lo, s64
    s_and_b32 s64, s64, s58
    s_cmp_eq_u32 s64, s58
    s_cbranch_scc1 L_early4_ok
    s_mov_b32 s62, 200000
L_early4_loop:
    buffer_load_dword v239, v238, s[20:23], 0 offen sc1
    s_waitcnt vmcnt(0)
    v_subrev_u32 v245, s36, v239
    v_cmp_le_u32 vcc, 6, v245
    v_cmp_ge_u32 s[64:65], 8, v245
    s_nop 1
    s_and_b32 s64, vcc_lo, s64
    s_and_b32 s64, s64, s58
    s_cmp_eq_u32 s64, s58
    s_cbranch_scc1 L_early4_ok
    s_sub_u32 s62, s62, 1
    s_cmp_lg_u32 s62, 0
    s_cbranch_scc1 L_early4_loop
L_early4_ok:
    s_mov_b64 vcc, 0
L_np1B:
    s_barrier
    buffer_load_dwordx4 v[164:167], v240, s[20:23], s40 offen offset:0 sc1
    buffer_load_dwordx4 v[168:171], v240, s[20:23], s40 offen offset:1024 sc1
    buffer_load_dwordx4 v[172:175], v240, s[20:23], s41 offen offset:0 sc1
    buffer_load_dwordx4 v[176:179], v240, s[20:23], s41 offen offset:1024 sc1
    buffer_load_dwordx4 v[180:183], v240, s[20:23], s42 offen offset:0 sc1
    buffer_load_dwordx4 v[184:187], v240, s[20:23], s42 offen offset:1024 sc1
    buffer_load_dwordx4 a[72:75], v240, s[20:23], s43 offen offset:0 sc1
    buffer_load_dwordx4 a[76:79], v240, s[20:23], s43 offen offset:1024 sc1
    buffer_load_dwordx4 a[80:83], v240, s[20:23], s44 offen offset:0 sc1
    buffer_load_dwordx4 a[84:87], v240, s[20:23], s44 offen offset:1024 sc1
    s_cmp_lt_u32 s29, 4
    s_cselect_b32 s37, 1, 0
    s_cmp_eq_u32 s30, 3
    s_cselect_b32 s37, s37, 0
    s_cmp_eq_u32 s37, 0
    s_cbranch_scc1 L_no8aB
    v_and_b32 v2, 63, v0
    v_lshlrev_b32 v8, 4, v2
    s_lshl_b32 s93, s29, 11
    v_add_u32 v8, s93, v8
    s_mov_b32 s94, 524288
    buffer_load_dwordx4 a[0:3], v8, s[20:23], s94 offen offset:0 sc1
    buffer_load_dwordx4 a[4:7], v8, s[20:23], s94 offen offset:1024 sc1
    s_mov_b32 s94, 532480
    buffer_load_dwordx4 a[8:11], v8, s[20:23], s94 offen offset:0 sc1
    buffer_load_dwordx4 a[12:15], v8, s[20:23], s94 offen offset:1024 sc1
    s_mov_b32 s94, 540672
    buffer_load_dwordx4 a[16:19], v8, s[20:23], s94 offen offset:0 sc1
    buffer_load_dwordx4 a[20:23], v8, s[20:23], s94 offen offset:1024 sc1
    s_mov_b32 s94, 548864
    buffer_load_dwordx4 a[24:27], v8, s[20:23], s94 offen offset:0 sc1
    buffer_load_dwordx4 a[28:31], v8, s[20:23], s94 offen offset:1024 sc1
    s_mov_b32 s94, 557056
    buffer_load_dwordx4 a[32:35], v8, s[20:23], s94 offen offset:0 sc1
    buffer_load_dwordx4 a[36:39], v8, s[20:23], s94 offen offset:1024 sc1
    s_mov_b32 s94, 565248
    buffer_load_dwordx4 a[40:43], v8, s[20:23], s94 offen offset:0 sc1
    buffer_load_dwordx4 a[44:47], v8, s[20:23], s94 offen offset:1024 sc1
    s_mov_b32 s94, 573440
    buffer_load_dwordx4 a[48:51], v8, s[20:23], s94 offen offset:0 sc1
    buffer_load_dwordx4 a[52:55], v8, s[20:23], s94 offen offset:1024 sc1
    s_mov_b32 s94, 581632
    buffer_load_dwordx4 a[56:59], v8, s[20:23], s94 offen offset:0 sc1
    buffer_load_dwordx4 a[60:63], v8, s[20:23], s94 offen offset:1024 sc1
    v_lshrrev_b32 v5, 4, v2
    v_and_b32 v6, 15, v2
    s_lshl_b32 s93, s29, 5
    s_add_u32 s93, s93, 1024
    v_lshlrev_b32 v9, 3, v5
    v_add_u32 v9, s93, v9
    buffer_load_dwordx2 a[64:65], v9, s[24:27], 0 offen
    buffer_load_dwordx2 a[66:67], v9, s[24:27], 0 offen
    v_and_b32 v14, 1, v5
    v_lshl_add_u32 v10, v14, 4, v6
    v_mul_u32_u24 v10, 1152, v10
    v_lshrrev_b32 v15, 1, v5
    v_lshl_add_u32 v10, v15, 4, v10
    v_add_u32 v10, s93, v10
L_no8aB:
    s_cmp_lg_u32 s30, 0
    s_cbranch_scc1 L_np2B
    v_subrev_u32 v245, s36, v239
    v_cmp_le_u32 vcc, 8, v245
    v_cmp_ge_u32 s[64:65], 8, v245
    s_nop 1
    s_and_b32 s64, vcc_lo, s64
    s_and_b32 s64, s64, s59
    s_cmp_eq_u32 s64, s59
    s_cbranch_scc1 L_late5_ok
    s_mov_b32 s62, 200000
L_late5_loop:
    buffer_load_dword v239, v238, s[20:23], 0 offen sc1
    s_waitcnt vmcnt(0)
    v_subrev_u32 v245, s36, v239
    v_cmp_le_u32 vcc, 8, v245
    v_cmp_ge_u32 s[64:65], 8, v245
    s_nop 1
    s_and_b32 s64, vcc_lo, s64
    s_and_b32 s64, s64, s59
    s_cmp_eq_u32 s64, s59
    s_cbranch_scc1 L_late5_ok
    s_sub_u32 s62, s62, 1
    s_cmp_lg_u32 s62, 0
    s_cbranch_scc1 L_late5_loop
L_late5_ok:
    s_mov_b64 vcc, 0
L_np2B:
    s_barrier
    buffer_load_dwordx4 a[88:91], v240, s[20:23], s45 offen offset:0 sc1
    buffer_load_dwordx4 a[92:95], v240, s[20:23], s45 offen offset:1024 sc1
    buffer_load_dwordx4 a[96:99], v240, s[20:23], s46 offen offset:0 sc1
    buffer_load_dwordx4 a[100:103], v240, s[20:23], s46 offen offset:1024 sc1
    s_waitcnt vmcnt(4)
    v_mfma_f32_16x16x32_bf16 v[32:35], v[228:231], v[188:191], v[32:35]
    v_mfma_f32_16x16x32_bf16 v[36:39], v[232:235], v[188:191], v[36:39]
    v_mfma_f32_16x16x32_bf16 v[40:43], v[228:231], v[188:191], v[40:43]
    v_mfma_f32_16x16x32_bf16 v[44:47], v[232:235], v[188:191], v[44:47]
    v_mfma_f32_16x16x32_bf16 v[32:35], v[228:231], v[164:167], v[32:35]
    v_mfma_f32_16x16x32_bf16 v[36:39], v[232:235], v[164:167], v[36:39]
    v_mfma_f32_16x16x32_bf16 v[40:43], v[228:231], v[168:171], v[40:43]
    v_mfma_f32_16x16x32_bf16 v[44:47], v[232:235], v[168:171], v[44:47]
    v_mfma_f32_16x16x32_bf16 v[32:35], v[228:231], v[172:175], v[32:35]
    v_mfma_f32_16x16x32_bf16 v[36:39], v[232:235], v[172:175], v[36:39]
    v_mfma_f32_16x16x32_bf16 v[40:43], v[228:231], v[176:179], v[40:43]
    v_mfma_f32_16x16x32_bf16 v[44:47], v[232:235], v[176:179], v[44:47]
    v_mfma_f32_16x16x32_bf16 v[32:35], v[228:231], v[180:183], v[32:35]
    v_mfma_f32_16x16x32_bf16 v[36:39], v[232:235], v[180:183], v[36:39]
    v_mfma_f32_16x16x32_bf16 v[40:43], v[228:231], v[184:187], v[40:43]
    v_mfma_f32_16x16x32_bf16 v[44:47], v[232:235], v[184:187], v[44:47]
    v_mfma_f32_16x16x32_bf16 v[32:35], v[228:231], a[72:75], v[32:35]
    v_mfma_f32_16x16x32_bf16 v[36:39], v[232:235], a[72:75], v[36:39]
    v_mfma_f32_16x16x32_bf16 v[40:43], v[228:231], a[76:79], v[40:43]
    v_mfma_f32_16x16x32_bf16 v[44:47], v[232:235], a[76:79], v[44:47]
    v_mfma_f32_16x16x32_bf16 v[32:35], v[228:231], a[80:83], v[32:35]
    v_mfma_f32_16x16x32_bf16 v[36:39], v[232:235], a[80:83], v[36:39]
    v_mfma_f32_16x16x32_bf16 v[40:43], v[228:231], a[84:87], v[40:43]
    v_mfma_f32_16x16x32_bf16 v[44:47], v[232:235], a[84:87], v[44:47]
    s_cmp_eq_u32 s37, 0
    s_cbranch_scc1 L_no8bB
    v_mfma_f32_16x16x32_bf16 v[16:19], v[228:231], a[64:67], 0
    v_mfma_f32_16x16x32_bf16 v[20:23], v[232:235], a[64:67], 0
    v_mfma_f32_16x16x32_bf16 v[24:27], v[228:231], a[64:67], 0
    v_mfma_f32_16x16x32_bf16 v[28:31], v[232:235], a[64:67], 0
    v_mfma_f32_16x16x32_bf16 v[16:19], v[228:231], a[0:3], v[16:19]
    v_mfma_f32_16x16x32_bf16 v[20:23], v[232:235], a[0:3], v[20:23]
    v_mfma_f32_16x16x32_bf16 v[24:27], v[228:231], a[4:7], v[24:27]
    v_mfma_f32_16x16x32_bf16 v[28:31], v[232:235], a[4:7], v[28:31]
    v_mfma_f32_16x16x32_bf16 v[16:19], v[228:231], a[8:11], v[16:19]
    v_mfma_f32_16x16x32_bf16 v[20:23], v[232:235], a[8:11], v[20:23]
    v_mfma_f32_16x16x32_bf16 v[24:27], v[228:231], a[12:15], v[24:27]
    v_mfma_f32_16x16x32_bf16 v[28:31], v[232:235], a[12:15], v[28:31]
    v_mfma_f32_16x16x32_bf16 v[16:19], v[228:231], a[16:19], v[16:19]
    v_mfma_f32_16x16x32_bf16 v[20:23], v[232:235], a[16:19], v[20:23]
    v_mfma_f32_16x16x32_bf16 v[24:27], v[228:231], a[20:23], v[24:27]
    v_mfma_f32_16x16x32_bf16 v[28:31], v[232:235], a[20:23], v[28:31]
    v_mfma_f32_16x16x32_bf16 v[16:19], v[228:231], a[24:27], v[16:19]
    v_mfma_f32_16x16x32_bf16 v[20:23], v[232:235], a[24:27], v[20:23]
    v_mfma_f32_16x16x32_bf16 v[24:27], v[228:231], a[28:31], v[24:27]
    v_mfma_f32_16x16x32_bf16 v[28:31], v[232:235], a[28:31], v[28:31]
    v_mfma_f32_16x16x32_bf16 v[16:19], v[228:231], a[32:35], v[16:19]
    v_mfma_f32_16x16x32_bf16 v[20:23], v[232:235], a[32:35], v[20:23]
    v_mfma_f32_16x16x32_bf16 v[24:27], v[228:231], a[36:39], v[24:27]
    v_mfma_f32_16x16x32_bf16 v[28:31], v[232:235], a[36:39], v[28:31]
    v_mfma_f32_16x16x32_bf16 v[16:19], v[228:231], a[40:43], v[16:19]
    v_mfma_f32_16x16x32_bf16 v[20:23], v[232:235], a[40:43], v[20:23]
    v_mfma_f32_16x16x32_bf16 v[24:27], v[228:231], a[44:47], v[24:27]
    v_mfma_f32_16x16x32_bf16 v[28:31], v[232:235], a[44:47], v[28:31]
    v_mfma_f32_16x16x32_bf16 v[16:19], v[228:231], a[48:51], v[16:19]
    v_mfma_f32_16x16x32_bf16 v[20:23], v[232:235], a[48:51], v[20:23]
    v_mfma_f32_16x16x32_bf16 v[24:27], v[228:231], a[52:55], v[24:27]
    v_mfma_f32_16x16x32_bf16 v[28:31], v[232:235], a[52:55], v[28:31]
    v_mfma_f32_16x16x32_bf16 v[16:19], v[228:231], a[56:59], v[16:19]
    v_mfma_f32_16x16x32_bf16 v[20:23], v[232:235], a[56:59], v[20:23]
    v_mfma_f32_16x16x32_bf16 v[24:27], v[228:231], a[60:63], v[24:27]
    v_mfma_f32_16x16x32_bf16 v[28:31], v[232:235], a[60:63], v[28:31]
    s_nop 7
    s_nop 0
    v_cvt_pk_bf16_f32 v84, v16, v17
    v_cvt_pk_bf16_f32 v85, v18, v19
    v_cvt_pk_bf16_f32 v86, v20, v21
    v_cvt_pk_bf16_f32 v87, v22, v23
    v_cvt_pk_bf16_f32 v88, v24, v25
    v_cvt_pk_bf16_f32 v89, v26, v27
    v_cvt_pk_bf16_f32 v90, v28, v29
    v_cvt_pk_bf16_f32 v91, v30, v31
    v_add_u32 v11, 36864, v10
    s_nop 0
    v_permlane16_swap_b32 v84, v86
    v_permlane16_swap_b32 v85, v87
    v_permlane16_swap_b32 v88, v90
    v_permlane16_swap_b32 v89, v91
    buffer_store_dwordx4 v[84:87], v10, s[8:11], 0 offen
    buffer_store_dwordx4 v[88:91], v11, s[8:11], 0 offen
L_no8bB:
    s_waitcnt vmcnt(0)
    v_mfma_f32_16x16x32_bf16 v[32:35], v[228:231], a[88:91], v[32:35]
    v_mfma_f32_16x16x32_bf16 v[36:39], v[232:235], a[88:91], v[36:39]
    v_mfma_f32_16x16x32_bf16 v[40:43], v[228:231], a[92:95], v[40:43]
    v_mfma_f32_16x16x32_bf16 v[44:47], v[232:235], a[92:95], v[44:47]
    v_mfma_f32_16x16x32_bf16 v[32:35], v[228:231], a[96:99], v[32:35]
    v_mfma_f32_16x16x32_bf16 v[36:39], v[232:235], a[96:99], v[36:39]
    v_mfma_f32_16x16x32_bf16 v[40:43], v[228:231], a[100:103], v[40:43]
    v_mfma_f32_16x16x32_bf16 v[44:47], v[232:235], a[100:103], v[44:47]
    s_nop 7
    s_nop 0
    v_cvt_pk_bf16_f32 v84, v32, v33
    v_cvt_pk_bf16_f32 v85, v34, v35
    v_cvt_pk_bf16_f32 v86, v36, v37
    v_cvt_pk_bf16_f32 v87, v38, v39
    v_cvt_pk_bf16_f32 v88, v40, v41
    v_cvt_pk_bf16_f32 v89, v42, v43
    v_cvt_pk_bf16_f32 v90, v44, v45
    v_cvt_pk_bf16_f32 v91, v46, v47
    v_add_u32 v11, 36864, v241
    s_nop 0
    v_permlane16_swap_b32 v84, v86
    v_permlane16_swap_b32 v85, v87
    v_permlane16_swap_b32 v88, v90
    v_permlane16_swap_b32 v89, v91
    buffer_store_dwordx4 v[84:87], v241, s[8:11], s75 offen
    buffer_store_dwordx4 v[88:91], v11, s[8:11], s75 offen
L_tail_done:
L_main_end:
    s_endpgm
.section .rodata,"a"
.p2align 6
.amdhsa_kernel standalone__dense_activation_squared_relu__prompt_kernel
  .amdhsa_next_free_vgpr 512
  .amdhsa_next_free_sgpr 102
  .amdhsa_accum_offset 256
  .amdhsa_group_segment_fixed_size 0
  .amdhsa_kernarg_size 64
  .amdhsa_user_sgpr_count 2
  .amdhsa_user_sgpr_kernarg_segment_ptr 1
  .amdhsa_system_sgpr_workgroup_id_x 1
.end_amdhsa_kernel
.text
```
